```python
import torch

def _softmax(x, axis=-1):
    return torch.softmax(x, dim=axis)

def _gelu(x):
    return torch.nn.functional.gelu(x, approximate='tanh')

def _silu(x):
    return torch.nn.functional.silu(x)

def _sigmoid(x):
    return torch.sigmoid(x)

def _layernorm(x, axis=-1, eps=1e-05):
    m = x.mean(dim=axis, keepdim=True)
    v = x.var(dim=axis, keepdim=True, unbiased=False)
    return (x - m) / torch.sqrt(v + eps)

def _scatter_add(tgt, idx, src, axis=0):
    return tgt.clone().index_add_(axis, idx, src)

def _segment_sum(src, seg, n):
    out = torch.zeros((n,) + src.shape[1:], dtype=src.dtype)
    return out.index_add_(0, seg, src)

def _pad(x, pw):
    flat = tuple((v for pair in reversed(pw) for v in pair))
    return torch.nn.functional.pad(x, flat)
kernel_name = 'adaLN_cond__linear_kernel_hedgehog__glu_gated_bilinear__prompt'

def setup_inputs():

    _w = lambda a: (lambda t: t.to(torch.bfloat16) if t.is_floating_point() else t)(torch.as_tensor(a))

    def _A_setup():
        B, S, D, H = (1, 2048, 512, 32)
        Dh = D // H
        return {'x': _w((lambda *s: torch.randn(*s, dtype=torch.bfloat16) * 0.1)(B, S, D)), 'wqkv': _w((lambda *s: torch.randn(*s, dtype=torch.bfloat16) * 0.2)(D, 3 * D)), 'w_phi': _w((lambda *s: torch.randn(*s, dtype=torch.bfloat16) * 0.2)(H, Dh, Dh) * Dh ** (-0.5)), 'wo': _w((lambda *s: torch.randn(*s, dtype=torch.bfloat16) * 0.2)(D, D))}
    _A_in = _A_setup()

    def _B_setup():
        B, S, D, F = (1, 2048, 512, 1376)
        return {'x': _w((lambda *s: torch.randn(*s, dtype=torch.bfloat16) * 0.1)(B, S, D)), 'w_gate': _w((lambda *s: torch.randn(*s, dtype=torch.bfloat16) * 3.2)(D, F) * D ** (-0.5)), 'w_up': _w((lambda *s: torch.randn(*s, dtype=torch.bfloat16) * 3.2)(D, F) * D ** (-0.5)), 'w_down': _w((lambda *s: torch.randn(*s, dtype=torch.bfloat16) * 3.2)(F, D) * F ** (-0.5))}
    _B_in = _B_setup()
    return {'A_x': _A_in['x'], 'A_wqkv': _A_in['wqkv'], 'A_w_phi': _A_in['w_phi'], 'A_wo': _A_in['wo'], 'B_x': _B_in['x'], 'B_w_gate': _B_in['w_gate'], 'B_w_up': _B_in['w_up'], 'B_w_down': _B_in['w_down'], 'c': _w((lambda *s: torch.randn(*s, dtype=torch.bfloat16) * 0.4)(1, 512) * 8.0), 'w_mod': _w((lambda *s: torch.randn(*s, dtype=torch.bfloat16) * 0.4)(512, 6 * 512) * 512 ** (-0.5) * 8.0)}

def reference(A_x, A_wqkv, A_w_phi, A_wo, B_x, B_w_gate, B_w_up, B_w_down, c, w_mod):

    def _A_ref(x, wqkv, w_phi, wo):
        B, S, D = x.shape
        H = 32
        Dh = D // H
        qkv = (lambda x, *d: x.permute(*d))((x @ wqkv).reshape(B, S, 3, H, Dh), 2, 0, 3, 1, 4)
        q, k, v = (qkv[0], qkv[1], qkv[2])
        pq = torch.einsum('bhsd,hdf->bhsf', q, w_phi)
        pk = torch.einsum('bhsd,hdf->bhsf', k, w_phi)
        phi_q = torch.concatenate([_softmax(pq, axis=-1), _softmax(-pq, axis=-1)], axis=-1)
        phi_k = torch.concatenate([_softmax(pk, axis=-1), _softmax(-pk, axis=-1)], axis=-1)
        kv = torch.einsum('bhsf,bhsd->bhfd', phi_k, v)
        z = torch.einsum('bhsf->bhf', phi_k)
        num = torch.einsum('bhqf,bhfd->bhqd', phi_q, kv)
        den = torch.einsum('bhqf,bhf->bhq', phi_q, z)[..., None] + 1e-06
        o = num / den
        return (lambda x, *d: x.permute(*d))(o, 0, 2, 1, 3).reshape(B, S, D) @ wo

    def _B_ref(x, w_gate, w_up, w_down):
        g = torch.einsum('bsd,df->bsf', x, w_gate)
        u = torch.einsum('bsd,df->bsf', x, w_up)
        h = g * u
        return torch.einsum('bsf,fd->bsd', h, w_down)
    x = A_x
    mod = (_silu(c) @ w_mod).reshape(c.shape[0], 6, 1, -1)
    sa, ca, ga, sb, cb, gb = (mod[:, 0].clone(), mod[:, 1].clone(), mod[:, 2].clone(), mod[:, 3].clone(), mod[:, 4].clone(), mod[:, 5].clone())
    h = _layernorm(x, axis=-1) * (1 + ca) + sa
    x = x + ga * _A_ref(h, A_wqkv, A_w_phi, A_wo)
    h = _layernorm(x, axis=-1) * (1 + cb) + sb
    x = x + gb * _B_ref(h, B_w_gate, B_w_up, B_w_down)
    return x
```

```asm
; @launch grid=(256,1,1) block=(256,1,1) lds=163840
.amdgcn_target "amdgcn-amd-amdhsa--gfx950"
.text
.globl adaLN_cond__linear_kernel_hedgehog__glu_gated_bilinear__prompt_kernel
.p2align 8
.type adaLN_cond__linear_kernel_hedgehog__glu_gated_bilinear__prompt_kernel,@function
adaLN_cond__linear_kernel_hedgehog__glu_gated_bilinear__prompt_kernel:
    s_cmp_ge_u32 s2, 256
    s_cbranch_scc1 L_END
    s_load_dwordx8 s[68:75], s[0:1], 0
    s_load_dwordx8 s[76:83], s[0:1], 40
    s_load_dwordx8 s[84:91], s[0:1], 72
    s_memrealtime s[92:93]
    s_bfe_u32 s28, s2, 0x10002
    s_lshl_b32 s28, s28, 3
    s_bfe_u32 s3, s2, 0x30003
    s_or_b32 s28, s28, s3
    s_and_b32 s29, s2, 3
    s_lshl_b32 s29, s29, 2
    s_lshr_b32 s3, s2, 6
    s_or_b32 s29, s29, s3
    v_lshrrev_b32 v2, 6, v0
    v_and_b32 v1, 63, v0
    v_readfirstlane_b32 s30, v2
    v_lshlrev_b32 v3, 4, v1
    v_lshrrev_b32 v6, 5, v1
    s_getpc_b64 s[58:59]
L_PC:
    s_lshr_b32 s3, s2, 3
    s_lshl_b32 s31, s3, 10
    v_lshlrev_b32 v5, 2, v0
    v_add_u32 v5, s31, v5
    v_min_u32 v5, L_CODE_END-L_PC-4, v5
    global_load_dword v252, v5, s[58:59]
    v_lshrrev_b32 v8, 3, v1
    v_and_b32 v9, 7, v1
    v_mul_u32_u24 v19, 6144, v8
    v_lshl_add_u32 v19, v9, 4, v19
    v_lshlrev_b32 v7, 1, v8
    v_lshrrev_b32 v14, 4, v1
    v_and_b32 v15, 15, v1
    v_xor_b32 v15, v15, v14
    v_lshlrev_b32 v15, 4, v15
    v_lshl_add_u32 v20, v14, 10, v15
    v_xor_b32 v21, 64, v20
    v_xor_b32 v22, 128, v20
    v_xor_b32 v23, 192, v20
    v_xor_b32 v12, v14, v8
    v_lshrrev_b32 v13, 2, v1
    v_xor_b32 v12, v12, v13
    v_and_b32 v12, 1, v12
    v_mul_u32_u24 v10, 3072, v8
    v_lshl_add_u32 v10, v12, 10, v10
    v_and_b32 v15, 3, v1
    v_lshl_add_u32 v10, v15, 4, v10
    v_mul_u32_u24 v11, 3072, v13
    v_lshl_add_u32 v11, v15, 4, v11
    s_lshl_b32 s35, s28, 17
    s_lshl_b32 s64, s30, 15
    s_add_u32 s35, s35, s64
    s_lshl_b32 s64, s30, 13
    s_mul_i32 s58, s30, 98304
    s_lshl_b32 s59, s29, 6
    s_add_u32 s58, s58, s59
    s_lshl_b32 s59, s30, 12
    s_add_u32 s59, s59, 65536
    s_and_b32 s33, s2, 3
    s_lshr_b32 s34, s2, 2
    s_lshl_b32 s31, s33, 2
    s_add_u32 s31, s31, s30
    s_lshl_b32 s31, s31, 5
    s_lshl_b32 s32, s31, 1
    s_mul_i32 s31, s31, 6144
    s_lshl_b32 s56, s34, 7
    s_add_u32 s31, s31, s56
    s_cmp_ge_u32 s2, 192
    s_cselect_b32 s31, 0x7f000000, s31
    s_lshl_b32 s3, s28, 7
    s_lshl_b32 s56, s29, 3
    s_add_u32 s3, s3, s56
    s_lshl_b32 s56, s30, 1
    s_add_u32 s3, s3, s56
    s_lshl_b32 s57, s3, 10
    s_waitcnt lgkmcnt(0)
    s_mov_b32 s60, s88
    s_and_b32 s61, s89, 0xffff
    s_mov_b32 s62, 256
    s_mov_b32 s63, 0x00020000
    s_cmp_lg_u32 s2, 0
    s_cbranch_scc1 NONONCE_1
    s_cmp_lg_u32 s30, 0
    s_cbranch_scc1 NONONCE_1
    s_or_b32 s92, s92, 1
    v_mov_b32 v2, s92
    s_mov_b64 exec, 1
    buffer_store_dword v2, off, s[60:63], 0 sc1
    s_mov_b64 exec, -1
NONONCE_1:
    s_mov_b32 s4, s82
    s_and_b32 s5, s83, 0xffff
    s_mov_b32 s6, 1028
    s_mov_b32 s7, 0x00020000
    s_mov_b32 s8, s84
    s_and_b32 s9, s85, 0xffff
    s_mov_b32 s10, 3145728
    s_mov_b32 s11, 0x00020000
    buffer_load_ushort v32, v7, s[4:7], s32 offen offset:0
    buffer_load_ushort v33, v7, s[4:7], s32 offen offset:16
    buffer_load_ushort v34, v7, s[4:7], s32 offen offset:32
    buffer_load_ushort v35, v7, s[4:7], s32 offen offset:48
    buffer_load_dwordx4 v[48:51], v19, s[8:11], s31 offen
    s_add_u32 s31, s31, 49152
    buffer_load_dwordx4 v[52:55], v19, s[8:11], s31 offen
    s_add_u32 s31, s31, 49152
    buffer_load_dwordx4 v[56:59], v19, s[8:11], s31 offen
    s_add_u32 s31, s31, 49152
    buffer_load_dwordx4 v[60:63], v19, s[8:11], s31 offen
    s_mov_b32 s12, s68
    s_and_b32 s13, s69, 0xffff
    s_mov_b32 s14, 2097152
    s_mov_b32 s15, 0x00020000
    buffer_load_dwordx4 v[64:67], v3, s[12:15], s57 offen
    buffer_load_dwordx4 v[68:71], v3, s[12:15], s57 offen offset:1024
    s_mov_b32 s16, s70
    s_and_b32 s17, s71, 0xffff
    s_mov_b32 s18, 1572864
    s_mov_b32 s19, 0x00020000
    s_lshl_b32 s56, s2, 2
    s_add_u32 s56, s56, s30
    s_mul_i32 s56, s56, 1536
    v_min_u32 v12, 11, v1
    v_lshlrev_b32 v12, 7, v12
    buffer_load_dword v252, v12, s[16:19], s56 offen
    s_mov_b32 s24, s90
    s_and_b32 s25, s91, 0xffff
    s_mov_b32 s26, 26214400
    s_mov_b32 s27, 0x00020000
    s_lshl_b32 s57, s28, 2
    s_add_u32 s57, s57, s30
    s_lshl_b32 s57, s57, 5
    s_lshl_b32 s56, s29, 1
    s_add_u32 s57, s57, s56
    s_lshl_b32 s57, s57, 10
    s_add_u32 s93, s57, 6291456
    v_mov_b32 v248, -1
    v_mov_b32 v249, -1
    v_mov_b32 v250, -1
    v_mov_b32 v251, -1
    s_mov_b32 s20, s72
    s_and_b32 s21, s73, 0xffff
    s_mov_b32 s22, 16384
    s_mov_b32 s23, 0x00020000
    s_mov_b32 s36, s74
    s_and_b32 s37, s75, 0xffff
    s_mov_b32 s38, 524288
    s_mov_b32 s39, 0x00020000
    s_mov_b32 s40, s76
    s_and_b32 s41, s77, 0xffff
    s_mov_b32 s42, 1409024
    s_mov_b32 s43, 0x00020000
    s_mov_b32 s44, s78
    s_and_b32 s45, s79, 0xffff
    s_mov_b32 s46, 1409024
    s_mov_b32 s47, 0x00020000
    s_mov_b32 s48, s80
    s_and_b32 s49, s81, 0xffff
    s_mov_b32 s50, 1409024
    s_mov_b32 s51, 0x00020000
    s_mov_b32 s52, s86
    s_and_b32 s53, s87, 0xffff
    s_mov_b32 s54, 2097152
    s_mov_b32 s55, 0x00020000
    v_mov_b32 v40, 0
    v_mov_b32 v41, 0
    v_mov_b32 v42, 0
    v_mov_b32 v43, 0
    v_mov_b32 v44, 0
    v_mov_b32 v45, 0
    v_mov_b32 v46, 0
    v_mov_b32 v47, 0
    v_mov_b32 v72, 0
    v_mov_b32 v73, 0
    v_mov_b32 v74, 0
    v_mov_b32 v75, 0
    s_mov_b32 s31, 0x3fb8aa3b
    v_lshlrev_b32 v16, 5, v9
    v_lshl_add_u32 v16, v6, 4, v16
    v_bfe_u32 v13, v1, 4, 1
    v_lshl_add_u32 v16, v13, 3, v16
    s_lshl_b32 s32, s30, 8
    s_add_u32 s32, s32, 161792
    v_add_u32 v16, s32, v16
    v_lshlrev_b32 v17, 2, v1
    v_add_u32 v17, 161792, v17
    s_waitcnt vmcnt(7)
    buffer_load_dword v253, off, s[60:63], 0 sc1
    v_lshlrev_b32 v32, 16, v32
    s_add_u32 s56, s35, 0
    v_lshlrev_b32 v33, 16, v33
    v_lshlrev_b32 v34, 16, v34
    v_lshlrev_b32 v35, 16, v35
    s_add_u32 m0, s64, 0
    v_mul_f32 v36, s31, v32
    v_mul_f32 v37, s31, v33
    v_mul_f32 v38, s31, v34
    buffer_load_dwordx4 v20, s[12:15], s56 offen lds
    v_mul_f32 v39, s31, v35
    v_exp_f32 v36, -v36
    v_exp_f32 v37, -v37
    s_add_u32 s56, s35, 4096
    v_exp_f32 v38, -v38
    v_exp_f32 v39, -v39
    v_add_f32 v36, 1.0, v36
    s_add_u32 m0, s64, 1024
    v_add_f32 v37, 1.0, v37
    v_add_f32 v38, 1.0, v38
    v_add_f32 v39, 1.0, v39
    v_rcp_f32 v12, v36
    buffer_load_dwordx4 v21, s[12:15], s56 offen lds
    v_mul_f32 v13, v32, v12
    v_fma_f32 v14, -v13, v36, v32
    v_fma_f32 v14, v14, v12, v13
    s_add_u32 s56, s35, 8192
    v_cmp_class_f32 vcc, v14, 3
    s_nop 1
    v_cndmask_b32 v32, v14, v13, vcc
    v_rcp_f32 v12, v37
    s_add_u32 m0, s64, 2048
    v_mul_f32 v13, v33, v12
    v_fma_f32 v14, -v13, v37, v33
    v_fma_f32 v14, v14, v12, v13
    buffer_load_dwordx4 v22, s[12:15], s56 offen lds
    v_cmp_class_f32 vcc, v14, 3
    s_nop 1
    v_cndmask_b32 v33, v14, v13, vcc
    v_rcp_f32 v12, v38
    s_nop 0
    v_mul_f32 v13, v34, v12
    s_add_u32 s56, s35, 12288
    v_fma_f32 v14, -v13, v38, v34
    v_fma_f32 v14, v14, v12, v13
    v_cmp_class_f32 vcc, v14, 3
    s_add_u32 m0, s64, 3072
    s_nop 0
    v_cndmask_b32 v34, v14, v13, vcc
    v_rcp_f32 v12, v39
    s_nop 0
    v_mul_f32 v13, v35, v12
    buffer_load_dwordx4 v23, s[12:15], s56 offen lds
    v_fma_f32 v14, -v13, v39, v35
    v_fma_f32 v14, v14, v12, v13
    v_cmp_class_f32 vcc, v14, 3
    s_add_u32 s56, s35, 16384
    s_nop 0
    v_cndmask_b32 v35, v14, v13, vcc
    v_cvt_pk_bf16_f32 v36, v32, v32
    v_lshlrev_b32 v32, 16, v36
    s_add_u32 m0, s64, 4096
    v_cvt_pk_bf16_f32 v37, v33, v33
    v_lshlrev_b32 v33, 16, v37
    v_cvt_pk_bf16_f32 v38, v34, v34
    v_lshlrev_b32 v34, 16, v38
    buffer_load_dwordx4 v20, s[12:15], s56 offen lds
    v_cvt_pk_bf16_f32 v39, v35, v35
    v_lshlrev_b32 v35, 16, v39
    s_waitcnt vmcnt(12)
    s_add_u32 s56, s35, 20480
    v_lshlrev_b32 v12, 16, v48
    v_and_b32 v13, 0xffff0000, v48
    v_fmac_f32 v40, v32, v12
    s_add_u32 m0, s64, 5120
    v_fmac_f32 v41, v32, v13
    v_lshlrev_b32 v12, 16, v49
    v_and_b32 v13, 0xffff0000, v49
    buffer_load_dwordx4 v21, s[12:15], s56 offen lds
    v_fmac_f32 v42, v32, v12
    v_fmac_f32 v43, v32, v13
    v_lshlrev_b32 v12, 16, v50
    v_and_b32 v13, 0xffff0000, v50
    s_add_u32 s56, s35, 24576
    v_fmac_f32 v44, v32, v12
    v_fmac_f32 v45, v32, v13
    v_lshlrev_b32 v12, 16, v51
    s_add_u32 m0, s64, 6144
    v_and_b32 v13, 0xffff0000, v51
    v_fmac_f32 v46, v32, v12
    v_fmac_f32 v47, v32, v13
    buffer_load_dwordx4 v22, s[12:15], s56 offen lds
    s_waitcnt vmcnt(13)
    v_lshlrev_b32 v12, 16, v52
    v_and_b32 v13, 0xffff0000, v52
    s_add_u32 s56, s35, 28672
    v_fmac_f32 v40, v33, v12
    v_fmac_f32 v41, v33, v13
    v_lshlrev_b32 v12, 16, v53
    s_add_u32 m0, s64, 7168
    v_and_b32 v13, 0xffff0000, v53
    v_fmac_f32 v42, v33, v12
    v_fmac_f32 v43, v33, v13
    v_lshlrev_b32 v12, 16, v54
    buffer_load_dwordx4 v23, s[12:15], s56 offen lds
    v_and_b32 v13, 0xffff0000, v54
    v_fmac_f32 v44, v33, v12
    v_fmac_f32 v45, v33, v13
    s_add_u32 s56, s58, 1024
    v_lshlrev_b32 v12, 16, v55
    v_and_b32 v13, 0xffff0000, v55
    v_fmac_f32 v46, v33, v12
    s_add_u32 m0, s59, 0
    v_fmac_f32 v47, v33, v13
    s_waitcnt vmcnt(13)
    v_lshlrev_b32 v12, 16, v56
    buffer_load_dwordx4 v10, s[16:19], s56 offen lds
    v_and_b32 v13, 0xffff0000, v56
    v_fmac_f32 v40, v34, v12
    v_fmac_f32 v41, v34, v13
    v_lshlrev_b32 v12, 16, v57
    s_add_u32 s56, s58, 25600
    v_and_b32 v13, 0xffff0000, v57
    v_fmac_f32 v42, v34, v12
    v_fmac_f32 v43, v34, v13
    s_add_u32 m0, s59, 1024
    v_lshlrev_b32 v12, 16, v58
    v_and_b32 v13, 0xffff0000, v58
    v_fmac_f32 v44, v34, v12
    buffer_load_dwordx4 v10, s[16:19], s56 offen lds
    v_fmac_f32 v45, v34, v13
    v_lshlrev_b32 v12, 16, v59
    v_and_b32 v13, 0xffff0000, v59
    s_add_u32 s56, s58, 50176
    v_fmac_f32 v46, v34, v12
    v_fmac_f32 v47, v34, v13
    s_waitcnt vmcnt(14)
    s_add_u32 m0, s59, 2048
    v_lshlrev_b32 v12, 16, v60
    v_and_b32 v13, 0xffff0000, v60
    v_fmac_f32 v40, v35, v12
    v_fmac_f32 v41, v35, v13
    buffer_load_dwordx4 v10, s[16:19], s56 offen lds
    v_lshlrev_b32 v12, 16, v61
    v_and_b32 v13, 0xffff0000, v61
    v_fmac_f32 v42, v35, v12
    s_add_u32 s56, s58, 74752
    v_fmac_f32 v43, v35, v13
    v_lshlrev_b32 v12, 16, v62
    v_and_b32 v13, 0xffff0000, v62
    s_add_u32 m0, s59, 3072
    v_fmac_f32 v44, v35, v12
    v_fmac_f32 v45, v35, v13
    v_lshlrev_b32 v12, 16, v63
    buffer_load_dwordx4 v10, s[16:19], s56 offen lds
    v_and_b32 v13, 0xffff0000, v63
    v_fmac_f32 v46, v35, v12
    v_fmac_f32 v47, v35, v13
    s_mov_b64 s[88:89], s[36:37]
    s_mov_b32 s90, s38
    s_mov_b32 s56, 16
    s_cmp_eq_u32 s30, 1
    s_cselect_b64 s[88:89], s[40:41], s[88:89]
    s_cselect_b32 s90, s42, s90
    s_cselect_b32 s56, 43, s56
    s_cmp_eq_u32 s30, 2
    s_cselect_b64 s[88:89], s[44:45], s[88:89]
    s_cselect_b32 s90, s46, s90
    s_cselect_b32 s56, 43, s56
    s_cmp_eq_u32 s30, 3
    s_cselect_b64 s[88:89], s[48:49], s[88:89]
    s_cselect_b32 s90, s50, s90
    s_cselect_b32 s56, 43, s56
    s_mov_b32 s91, 0x00020000
    s_mul_i32 s57, s2, s56
    s_lshl_b32 s57, s57, 7
    s_sub_u32 s56, s56, 1
    v_min_u32 v77, s56, v1
    v_lshlrev_b32 v77, 7, v77
    buffer_load_dword v252, v77, s[88:91], s57 offen
    v_permlane32_swap_b32 v40, v44
    v_permlane32_swap_b32 v41, v45
    v_permlane32_swap_b32 v42, v46
    v_permlane32_swap_b32 v43, v47
    v_add_f32 v40, v40, v44
    v_add_f32 v41, v41, v45
    v_add_f32 v42, v42, v46
    v_add_f32 v43, v43, v47
    s_nop 0
    v_permlane16_swap_b32 v40, v42
    v_permlane16_swap_b32 v41, v43
    v_add_f32 v40, v40, v42
    v_add_f32 v41, v41, v43
    s_nop 0
    v_add_f32_dpp v40, v40, v40 row_ror:8 row_mask:0xf bank_mask:0xf
    v_add_f32_dpp v41, v41, v41 row_ror:8 row_mask:0xf bank_mask:0xf
    ds_write_b64 v16, v[40:41]
    s_mov_b32 s57, 0x3f803f80
    s_waitcnt vmcnt(15)
    v_dot2c_f32_bf16 v72, s57, v64
    v_dot2c_f32_bf16 v73, v64, v64
    v_dot2c_f32_bf16 v72, s57, v65
    v_dot2c_f32_bf16 v73, v65, v65
    v_dot2c_f32_bf16 v72, s57, v66
    v_dot2c_f32_bf16 v73, v66, v66
    v_dot2c_f32_bf16 v72, s57, v67
    v_dot2c_f32_bf16 v73, v67, v67
    v_dot2c_f32_bf16 v74, s57, v68
    v_dot2c_f32_bf16 v75, v68, v68
    v_dot2c_f32_bf16 v74, s57, v69
    v_dot2c_f32_bf16 v75, v69, v69
    v_dot2c_f32_bf16 v74, s57, v70
    v_dot2c_f32_bf16 v75, v70, v70
    v_dot2c_f32_bf16 v74, s57, v71
    v_dot2c_f32_bf16 v75, v71, v71
    s_and_b32 s4, s34, 7
    s_lshl_b32 s4, s4, 12
    s_cmp_lt_u32 s34, 8
    v_permlane32_swap_b32 v72, v74
    v_permlane32_swap_b32 v73, v75
    s_cselect_b32 s5, 32, 0
    s_add_u32 s4, s4, s5
    v_add_f32 v72, v72, v74
    v_add_f32 v73, v73, v75
    s_add_u32 s4, s4, 0
    s_sub_u32 s5, s34, 16
    v_permlane16_swap_b32 v72, v73
    s_lshl_b32 s5, s5, 11
    v_add_f32 v72, v72, v73
    s_add_u32 s5, s5, 32768
    s_cmp_lt_u32 s34, 16
    v_add_f32_dpp v72, v72, v72 row_ror:1 row_mask:0xf bank_mask:0xf
    s_cselect_b32 s4, s4, s5
    s_cselect_b32 s5, 6, 5
    v_add_f32_dpp v72, v72, v72 row_ror:2 row_mask:0xf bank_mask:0xf
    s_lshl_b32 s6, s33, 3
    s_add_u32 s4, s4, s6
    v_add_f32_dpp v72, v72, v72 row_ror:4 row_mask:0xf bank_mask:0xf
    s_cmp_ge_u32 s2, 192
    s_cselect_b32 s4, 0x7f000000, s4
    v_add_f32_dpp v72, v72, v72 row_ror:8 row_mask:0xf bank_mask:0xf
    s_cmp_lg_u32 s30, 0
    s_cselect_b32 s4, 0x7f000000, s4
    v_mov_b32 v73, v72
    v_lshlrev_b32 v18, s5, v1
    v_lshlrev_b32 v76, 3, v6
    v_permlane16_swap_b32 v72, v73
    s_waitcnt lgkmcnt(0)
    s_barrier
    ds_read_b32 v40, v17 offset:0
    ds_read_b32 v41, v17 offset:256
    ds_read_b32 v42, v17 offset:512
    ds_read_b32 v43, v17 offset:768
    v_mul_f32 v72, 0x3b000000, v72
    v_mul_f32 v73, 0x3b000000, v73
    v_fma_f32 v73, -v72, v72, v73
    v_max_f32 v73, 0, v73
    v_cvt_pk_bf16_f32 v74, v73, v73
    v_lshlrev_b32 v73, 16, v74
    v_add_f32 v73, 0x3727c5ac, v73
    v_cvt_pk_bf16_f32 v74, v73, v73
    v_lshlrev_b32 v73, 16, v74
    v_sqrt_f32 v73, v73
    s_lshl_b32 s3, s3, 3
    s_add_u32 s3, s3, 98304
    v_cvt_pk_bf16_f32 v74, -v72, v73
    s_mov_b32 s57, 0
    s_waitcnt vmcnt(13)
    s_branch PNC_3
PN_2:
    buffer_load_dword v253, off, s[60:63], 0 sc1
    s_add_u32 s57, s57, 1
    s_waitcnt vmcnt(0)
PNC_3:
    v_readfirstlane_b32 s65, v253
    s_cmp_ge_u32 s57, 100000
    s_cbranch_scc1 PND_4
    s_cmp_eq_u32 s65, 0
    s_cbranch_scc1 PN_2
PND_4:
    s_waitcnt lgkmcnt(0)
    v_add_f32 v40, v40, v41
    v_add_f32 v42, v42, v43
    v_mov_b32 v41, s65
    v_add_f32 v40, v40, v42
    v_mov_b32 v75, s65
    buffer_store_dwordx2 v[40:41], v18, s[24:27], s4 offen sc1
    s_mov_b32 exec_lo, 1
    s_mov_b32 exec_hi, 1
    buffer_store_dwordx2 v[74:75], v76, s[24:27], s3 offen sc1
    s_mov_b64 exec, -1
    s_and_b32 s31, s29, 7
    s_lshr_b32 s32, s29, 3
    s_and_b32 s33, s30, 1
    s_lshr_b32 s34, s30, 1
    s_lshl_b32 s10, s30, 13
    s_add_u32 s10, s10, 0
    s_add_u32 s11, s10, 4096
    v_and_b32 v12, 31, v1
    s_add_u32 s56, s35, 256
    v_and_b32 v2, 15, v1
    v_xor_b32 v2, v2, v6
    s_add_u32 m0, s64, 32768
    v_lshlrev_b32 v2, 4, v2
    v_lshl_add_u32 v2, v12, 8, v2
    v_add_u32 v2, s64, v2
    buffer_load_dwordx4 v20, s[12:15], s56 offen lds
    v_xor_b32 v32, 0, v2
    v_xor_b32 v33, 32, v2
    v_xor_b32 v34, 64, v2
    s_add_u32 s56, s35, 4352
    v_xor_b32 v35, 96, v2
    v_xor_b32 v36, 128, v2
    s_add_u32 m0, s64, 33792
    v_xor_b32 v37, 160, v2
    v_xor_b32 v38, 192, v2
    v_xor_b32 v39, 224, v2
    buffer_load_dwordx4 v21, s[12:15], s56 offen lds
    v_bfe_u32 v15, v1, 4, 1
    v_and_b32 v14, 1, v1
    v_lshlrev_b32 v14, 4, v14
    s_add_u32 s56, s35, 8448
    v_lshl_add_u32 v14, v15, 5, v14
    v_bfe_u32 v15, v1, 1, 1
    v_lshl_add_u32 v14, v15, 3, v14
    s_add_u32 m0, s64, 34816
    v_bfe_u32 v15, v1, 4, 1
    v_and_b32 v5, 3, v1
    buffer_load_dwordx4 v22, s[12:15], s56 offen lds
    v_lshlrev_b32 v5, 3, v5
    v_lshl_add_u32 v5, v15, 5, v5
    v_bfe_u32 v2, v1, 2, 2
    s_add_u32 s56, s35, 12544
    v_lshl_add_u32 v15, v6, 3, v2
    v_lshrrev_b32 v13, 1, v2
    v_xor_b32 v13, v13, v2
    s_add_u32 m0, s64, 35840
    v_and_b32 v13, 1, v13
    v_lshl_add_u32 v16, v15, 7, v14
    buffer_load_dwordx4 v23, s[12:15], s56 offen lds
    v_lshl_add_u32 v16, v13, 6, v16
    v_add_u32 v16, 65536, v16
    v_xor_b32 v13, 1, v13
    s_add_u32 s56, s35, 16640
    v_lshl_add_u32 v17, v15, 7, v5
    v_lshl_add_u32 v17, v13, 6, v17
    v_add_u32 v17, 65536, v17
    s_add_u32 m0, s64, 36864
    v_lshl_add_u32 v18, v15, 6, v14
    v_and_b32 v13, 19, v1
    v_bfe_u32 v14, v1, 2, 1
    buffer_load_dwordx4 v20, s[12:15], s56 offen lds
    v_lshl_add_u32 v13, v14, 3, v13
    v_bfe_u32 v15, v1, 3, 1
    s_add_u32 s56, s35, 20736
    v_lshl_add_u32 v13, v15, 2, v13
    v_lshlrev_b32 v19, 2, v13
    v_add_u32 v19, 159744, v19
    s_add_u32 m0, s64, 37888
    v_xor_b32 v14, v14, v6
    v_bfe_u32 v13, v1, 1, 1
    v_lshl_add_u32 v13, v15, 1, v13
    buffer_load_dwordx4 v21, s[12:15], s56 offen lds
    v_bfe_u32 v15, v1, 4, 1
    v_lshl_add_u32 v13, v15, 2, v13
    v_lshl_add_u32 v13, v14, 3, v13
    s_add_u32 s56, s35, 24832
    v_and_b32 v14, 1, v1
    v_lshlrev_b32 v14, 4, v14
    s_add_u32 m0, s64, 38912
    v_mov_b32 v15, 0xffff
    v_lshlrev_b32 v14, v14, v15
    v_cmp_eq_u32 vcc, 0, v13
    buffer_load_dwordx4 v22, s[12:15], s56 offen lds
    s_nop 0
    v_cndmask_b32 v40, 0, v14, vcc
    v_cmp_eq_u32 vcc, 1, v13
    s_nop 1
    v_cndmask_b32 v41, 0, v14, vcc
    s_add_u32 s56, s35, 28928
    v_cmp_eq_u32 vcc, 2, v13
    s_nop 1
    v_cndmask_b32 v42, 0, v14, vcc
    s_add_u32 m0, s64, 39936
    v_cmp_eq_u32 vcc, 3, v13
    s_nop 1
    v_cndmask_b32 v43, 0, v14, vcc
    v_cmp_eq_u32 vcc, 4, v13
    buffer_load_dwordx4 v23, s[12:15], s56 offen lds
    s_nop 0
    v_cndmask_b32 v44, 0, v14, vcc
    v_cmp_eq_u32 vcc, 5, v13
    s_nop 1
    v_cndmask_b32 v45, 0, v14, vcc
    s_add_u32 s56, s58, 394240
    v_cmp_eq_u32 vcc, 6, v13
    s_nop 1
    v_cndmask_b32 v46, 0, v14, vcc
    v_cmp_eq_u32 vcc, 7, v13
    s_add_u32 m0, s59, 16384
    s_nop 0
    v_cndmask_b32 v47, 0, v14, vcc
    v_and_b32 v7, 0x3e, v1
    buffer_load_dwordx4 v10, s[16:19], s56 offen lds
    s_lshl_b32 s4, s30, 9
    s_add_u32 s4, s4, 159744
    v_add_u32 v7, s4, v7
    s_add_u32 s56, s58, 418816
    v_and_b32 v27, 31, v1
    v_lshlrev_b32 v26, 2, v27
    v_lshlrev_b32 v27, 3, v27
    s_add_u32 m0, s59, 17408
    s_lshl_b32 s3, s28, 2
    s_add_u32 s3, s3, s30
    buffer_load_dwordx4 v10, s[16:19], s56 offen lds
    s_lshl_b32 s3, s3, 8
    s_add_u32 s3, s3, 98304
    s_lshl_b32 s4, s30, 7
    s_add_u32 s56, s58, 443392
    s_add_u32 s4, s4, 162816
    v_add_u32 v26, s4, v26
    v_lshlrev_b32 v25, 4, v6
    s_add_u32 m0, s59, 18432
    v_add_u32 v25, s4, v25
    v_and_b32 v9, 1, v1
    v_lshlrev_b32 v9, 9, v9
    buffer_load_dwordx4 v10, s[16:19], s56 offen lds
    v_lshl_add_u32 v9, v6, 8, v9
    v_bfe_u32 v15, v1, 2, 2
    s_add_u32 s56, s58, 467968
    v_lshl_add_u32 v9, v15, 5, v9
    v_bfe_u32 v15, v1, 4, 1
    v_lshl_add_u32 v9, v15, 4, v9
    s_add_u32 m0, s59, 19456
    v_bfe_u32 v15, v1, 1, 1
    v_lshl_add_u32 v9, v15, 3, v9
    s_lshl_b32 s4, s30, 10
    buffer_load_dwordx4 v10, s[16:19], s56 offen lds
    s_add_u32 s4, s4, 147456
    v_add_u32 v9, s4, v9
    s_waitcnt vmcnt(19)
    ds_read_b128 a[0:3], v32 offset:0
    ds_read_b128 a[4:7], v33 offset:0
    ds_read_b128 a[8:11], v34 offset:0
    ds_read_b128 a[12:15], v35 offset:0
    ds_read_b128 a[16:19], v36 offset:0
    ds_read_b128 a[20:23], v37 offset:0
    ds_read_b128 a[24:27], v38 offset:0
    ds_read_b128 a[28:31], v39 offset:0
    s_lshl_b32 s5, s29, 10
    s_mov_b32 m0, s4
    s_nop 0
    buffer_load_dwordx4 v3, s[20:23], s5 offen lds
    buffer_load_dwordx2 v[28:29], v27, s[24:27], s3 offen sc1
    buffer_load_dwordx4 v[96:99], v3, s[24:27], s10 offen offset:0 sc1
    buffer_load_dwordx4 v[100:103], v3, s[24:27], s10 offen offset:1024 sc1
    buffer_load_dwordx4 v[104:107], v3, s[24:27], s10 offen offset:2048 sc1
    buffer_load_dwordx4 v[108:111], v3, s[24:27], s10 offen offset:3072 sc1
    buffer_load_dwordx4 v[112:115], v3, s[24:27], s11 offen offset:0 sc1
    buffer_load_dwordx4 v[116:119], v3, s[24:27], s11 offen offset:1024 sc1
    buffer_load_dwordx4 v[120:123], v3, s[24:27], s11 offen offset:2048 sc1
    buffer_load_dwordx4 v[124:127], v3, s[24:27], s11 offen offset:3072 sc1
    s_waitcnt lgkmcnt(0)
    s_add_u32 s56, s35, 512
    s_add_u32 m0, s64, 0
    s_nop 0
    buffer_load_dwordx4 v20, s[12:15], s56 offen lds
    s_add_u32 s56, s35, 4608
    s_add_u32 m0, s64, 1024
    s_nop 0
    buffer_load_dwordx4 v21, s[12:15], s56 offen lds
    s_add_u32 s56, s35, 8704
    s_add_u32 m0, s64, 2048
    s_nop 0
    buffer_load_dwordx4 v22, s[12:15], s56 offen lds
    s_add_u32 s56, s35, 12800
    s_add_u32 m0, s64, 3072
    s_nop 0
    buffer_load_dwordx4 v23, s[12:15], s56 offen lds
    s_add_u32 s56, s35, 16896
    s_add_u32 m0, s64, 4096
    s_nop 0
    buffer_load_dwordx4 v20, s[12:15], s56 offen lds
    s_add_u32 s56, s35, 20992
    s_add_u32 m0, s64, 5120
    s_nop 0
    buffer_load_dwordx4 v21, s[12:15], s56 offen lds
    s_add_u32 s56, s35, 25088
    s_add_u32 m0, s64, 6144
    s_nop 0
    buffer_load_dwordx4 v22, s[12:15], s56 offen lds
    s_add_u32 s56, s35, 29184
    s_add_u32 m0, s64, 7168
    s_nop 0
    buffer_load_dwordx4 v23, s[12:15], s56 offen lds
    s_waitcnt vmcnt(22)
    ds_read_b128 a[32:35], v32 offset:32768
    ds_read_b128 a[36:39], v33 offset:32768
    ds_read_b128 a[40:43], v34 offset:32768
    ds_read_b128 a[44:47], v35 offset:32768
    ds_read_b128 a[48:51], v36 offset:32768
    ds_read_b128 a[52:55], v37 offset:32768
    ds_read_b128 a[56:59], v38 offset:32768
    ds_read_b128 a[60:63], v39 offset:32768
    v_mov_b32 v12, s65
    v_and_b32 v13, 2, v1
    v_cmp_eq_u32 s[8:9], 0, v13
    s_mov_b32 s7, 0x01000100
    s_mov_b32 s57, 0
    s_waitcnt vmcnt(8)
    s_branch P0C_6
    s_nop 0
P0_5:
    buffer_load_dwordx2 v[28:29], v27, s[24:27], s3 offen sc1
    buffer_load_dwordx4 v[96:99], v3, s[24:27], s10 offen offset:0 sc1
    buffer_load_dwordx4 v[100:103], v3, s[24:27], s10 offen offset:1024 sc1
    buffer_load_dwordx4 v[104:107], v3, s[24:27], s10 offen offset:2048 sc1
    buffer_load_dwordx4 v[108:111], v3, s[24:27], s10 offen offset:3072 sc1
    buffer_load_dwordx4 v[112:115], v3, s[24:27], s11 offen offset:0 sc1
    buffer_load_dwordx4 v[116:119], v3, s[24:27], s11 offen offset:1024 sc1
    buffer_load_dwordx4 v[120:123], v3, s[24:27], s11 offen offset:2048 sc1
    buffer_load_dwordx4 v[124:127], v3, s[24:27], s11 offen offset:3072 sc1
    s_add_u32 s57, s57, 1
    s_waitcnt vmcnt(0)
P0C_6:
    s_cmp_ge_u32 s57, 100000
    s_cbranch_scc1 P0D_7
    v_xor_b32 v13, v29, v12
    v_bitop3_b32 v13, v13, v97, v12 bitop3:0xf6
    v_bitop3_b32 v13, v13, v99, v12 bitop3:0xf6
    v_bitop3_b32 v13, v13, v101, v12 bitop3:0xf6
    v_bitop3_b32 v13, v13, v103, v12 bitop3:0xf6
    v_bitop3_b32 v13, v13, v105, v12 bitop3:0xf6
    v_bitop3_b32 v13, v13, v107, v12 bitop3:0xf6
    v_bitop3_b32 v13, v13, v109, v12 bitop3:0xf6
    v_bitop3_b32 v13, v13, v111, v12 bitop3:0xf6
    v_bitop3_b32 v13, v13, v113, v12 bitop3:0xf6
    v_bitop3_b32 v13, v13, v115, v12 bitop3:0xf6
    v_bitop3_b32 v13, v13, v117, v12 bitop3:0xf6
    v_bitop3_b32 v13, v13, v119, v12 bitop3:0xf6
    v_bitop3_b32 v13, v13, v121, v12 bitop3:0xf6
    v_bitop3_b32 v13, v13, v123, v12 bitop3:0xf6
    v_bitop3_b32 v13, v13, v125, v12 bitop3:0xf6
    v_bitop3_b32 v13, v13, v127, v12 bitop3:0xf6
    v_cmp_ne_u32 vcc, 0, v13
    s_cbranch_vccnz P0_5
P0D_7:
    v_add_f32 v96, v96, v98
    v_add_f32 v100, v100, v102
    v_add_f32 v104, v104, v106
    v_add_f32 v108, v108, v110
    v_add_f32 v112, v112, v114
    v_add_f32 v116, v116, v118
    v_add_f32 v120, v120, v122
    v_add_f32 v124, v124, v126
    v_add_f32_dpp v96, v96, v96 quad_perm:[1,0,3,2] row_mask:0xf bank_mask:0xf
    v_add_f32_dpp v100, v100, v100 quad_perm:[1,0,3,2] row_mask:0xf bank_mask:0xf
    v_add_f32_dpp v104, v104, v104 quad_perm:[1,0,3,2] row_mask:0xf bank_mask:0xf
    v_add_f32_dpp v108, v108, v108 quad_perm:[1,0,3,2] row_mask:0xf bank_mask:0xf
    v_add_f32_dpp v112, v112, v112 quad_perm:[1,0,3,2] row_mask:0xf bank_mask:0xf
    v_add_f32_dpp v116, v116, v116 quad_perm:[1,0,3,2] row_mask:0xf bank_mask:0xf
    v_add_f32_dpp v120, v120, v120 quad_perm:[1,0,3,2] row_mask:0xf bank_mask:0xf
    v_add_f32_dpp v124, v124, v124 quad_perm:[1,0,3,2] row_mask:0xf bank_mask:0xf
    v_cvt_pk_bf16_f32 v96, v96, v96
    v_cvt_pk_bf16_f32 v100, v100, v100
    v_cvt_pk_bf16_f32 v104, v104, v104
    v_cvt_pk_bf16_f32 v108, v108, v108
    v_cvt_pk_bf16_f32 v112, v112, v112
    v_cvt_pk_bf16_f32 v116, v116, v116
    v_cvt_pk_bf16_f32 v120, v120, v120
    v_cvt_pk_bf16_f32 v124, v124, v124
    v_lshlrev_b32 v97, 16, v96
    v_lshlrev_b32 v101, 16, v100
    v_lshlrev_b32 v105, 16, v104
    v_lshlrev_b32 v109, 16, v108
    v_lshlrev_b32 v113, 16, v112
    v_lshlrev_b32 v117, 16, v116
    v_lshlrev_b32 v121, 16, v120
    v_lshlrev_b32 v125, 16, v124
    v_add_f32 v97, 1.0, v97
    v_add_f32 v101, 1.0, v101
    v_add_f32 v105, 1.0, v105
    v_add_f32 v109, 1.0, v109
    v_add_f32 v113, 1.0, v113
    v_add_f32 v117, 1.0, v117
    v_add_f32 v121, 1.0, v121
    v_add_f32 v125, 1.0, v125
    v_cvt_pk_bf16_f32 v97, v97, v97
    v_cvt_pk_bf16_f32 v101, v101, v101
    v_cvt_pk_bf16_f32 v105, v105, v105
    v_cvt_pk_bf16_f32 v109, v109, v109
    v_cvt_pk_bf16_f32 v113, v113, v113
    v_cvt_pk_bf16_f32 v117, v117, v117
    v_cvt_pk_bf16_f32 v121, v121, v121
    v_cvt_pk_bf16_f32 v125, v125, v125
    v_cndmask_b32 v96, v96, v97, s[8:9]
    ds_write_b16 v7, v96 offset:0
    v_cndmask_b32 v100, v100, v101, s[8:9]
    ds_write_b16 v7, v100 offset:64
    v_cndmask_b32 v104, v104, v105, s[8:9]
    ds_write_b16 v7, v104 offset:128
    v_cndmask_b32 v108, v108, v109, s[8:9]
    ds_write_b16 v7, v108 offset:192
    v_cndmask_b32 v112, v112, v113, s[8:9]
    ds_write_b16 v7, v112 offset:256
    v_cndmask_b32 v116, v116, v117, s[8:9]
    ds_write_b16 v7, v116 offset:320
    v_cndmask_b32 v120, v120, v121, s[8:9]
    ds_write_b16 v7, v120 offset:384
    v_cndmask_b32 v124, v124, v125, s[8:9]
    ds_write_b16 v7, v124 offset:448
    v_and_b32 v24, 0xffff0000, v28
    v_cmp_gt_u32 vcc, 32, v1
    v_rcp_f32 v24, v24
    v_mov_b32 v29, 0
    v_mov_b32 v30, 0
    v_mov_b32 v31, 0
    v_cndmask_b32 v28, 0, v28, vcc
    ds_write_b32 v26, v24
    s_waitcnt lgkmcnt(0)
    s_barrier
    v_mul_f32 v24, 0x3fb8aa3b, v24
    v_mov_b32 v49, 0
    v_mov_b32 v53, 0
    v_mov_b32 v50, 0
    v_mov_b32 v54, 0
    v_mov_b32 v51, 0
    v_mov_b32 v55, 0
    ds_read_b32 v48, v19 offset:0
    ds_read_b32 v52, v19 offset:128
    ds_read_b64_tr_b16 a[144:145], v16 offset:0
    ds_read_b64_tr_b16 a[146:147], v16 offset:512
    ds_read_b64_tr_b16 a[148:149], v17 offset:0
    ds_read_b64_tr_b16 a[150:151], v17 offset:512
    ds_read_b64_tr_b16 a[152:153], v16 offset:2048
    ds_read_b64_tr_b16 a[154:155], v16 offset:2560
    ds_read_b64_tr_b16 a[156:157], v17 offset:2048
    ds_read_b64_tr_b16 a[158:159], v17 offset:2560
    s_waitcnt lgkmcnt(9)
    v_perm_b32 v2, v48, v48, s7
    v_and_b32 v56, v2, v40
    v_and_b32 v57, v2, v41
    v_and_b32 v58, v2, v42
    v_and_b32 v59, v2, v43
    v_and_b32 v60, v2, v44
    v_and_b32 v61, v2, v45
    v_and_b32 v62, v2, v46
    v_and_b32 v63, v2, v47
    v_mfma_f32_32x32x16_bf16 v[192:207], v[48:51], v[28:31], 0
    v_mfma_f32_32x32x16_bf16 v[192:207], v[56:59], a[0:3], v[192:207]
    v_mfma_f32_32x32x16_bf16 v[192:207], v[60:63], a[4:7], v[192:207]
    s_waitcnt lgkmcnt(8)
    v_perm_b32 v2, v52, v52, s7
    v_and_b32 v56, v2, v40
    v_and_b32 v57, v2, v41
    v_and_b32 v58, v2, v42
    v_and_b32 v59, v2, v43
    v_and_b32 v60, v2, v44
    v_and_b32 v61, v2, v45
    v_and_b32 v62, v2, v46
    v_and_b32 v63, v2, v47
    v_mfma_f32_32x32x16_bf16 v[208:223], v[52:55], v[28:31], 0
    s_nop 0
    v_cvt_pk_bf16_f32 v64, v192, v193
    v_cvt_pk_bf16_f32 v65, v194, v195
    v_cvt_pk_bf16_f32 v66, v196, v197
    v_cvt_pk_bf16_f32 v67, v198, v199
    v_mfma_f32_32x32x16_bf16 v[208:223], v[56:59], a[8:11], v[208:223]
    v_cvt_pk_bf16_f32 v68, v200, v201
    v_cvt_pk_bf16_f32 v69, v202, v203
    v_cvt_pk_bf16_f32 v70, v204, v205
    v_cvt_pk_bf16_f32 v71, v206, v207
    v_mfma_f32_32x32x16_bf16 v[208:223], v[60:63], a[12:15], v[208:223]
    ds_read_b64_tr_b16 a[160:161], v16 offset:4096
    ds_read_b64_tr_b16 a[162:163], v16 offset:4608
    ds_read_b64_tr_b16 a[164:165], v17 offset:4096
    ds_read_b64_tr_b16 a[166:167], v17 offset:4608
    s_waitcnt lgkmcnt(8)
    v_mfma_f32_32x32x16_bf16 v[224:239], a[144:147], v[64:67], 0
    ds_read_b32 v48, v19 offset:256
    s_add_u32 s56, s58, 787456
    s_add_u32 m0, s59, 32768
    s_nop 0
    buffer_load_dwordx4 v10, s[16:19], s56 offen lds
    s_add_u32 s56, s58, 812032
    v_mfma_f32_32x32x16_bf16 a[128:143], v[64:67], a[148:151], 0
    ds_read_b64_tr_b16 a[168:169], v16 offset:6144
    ds_read_b64_tr_b16 a[170:171], v16 offset:6656
    ds_read_b64_tr_b16 a[172:173], v17 offset:6144
    ds_read_b64_tr_b16 a[174:175], v17 offset:6656
    s_waitcnt lgkmcnt(9)
    v_mfma_f32_32x32x16_bf16 v[224:239], a[152:155], v[68:71], v[224:239]
    s_add_u32 m0, s59, 33792
    s_nop 0
    buffer_load_dwordx4 v10, s[16:19], s56 offen lds
    s_add_u32 s56, s58, 836608
    s_add_u32 m0, s59, 34816
    s_nop 0
    buffer_load_dwordx4 v10, s[16:19], s56 offen lds
    v_mfma_f32_32x32x16_bf16 a[128:143], v[68:71], a[156:159], a[128:143]
    s_waitcnt lgkmcnt(4)
    v_perm_b32 v2, v48, v48, s7
    v_and_b32 v56, v2, v40
    v_and_b32 v57, v2, v41
    v_and_b32 v58, v2, v42
    v_and_b32 v59, v2, v43
    v_and_b32 v60, v2, v44
    v_and_b32 v61, v2, v45
    v_and_b32 v62, v2, v46
    v_and_b32 v63, v2, v47
    v_mfma_f32_32x32x16_bf16 v[192:207], v[48:51], v[28:31], 0
    v_cvt_pk_bf16_f32 v72, v208, v209
    v_cvt_pk_bf16_f32 v73, v210, v211
    v_cvt_pk_bf16_f32 v74, v212, v213
    v_cvt_pk_bf16_f32 v75, v214, v215
    v_mfma_f32_32x32x16_bf16 v[192:207], v[56:59], a[16:19], v[192:207]
    v_cvt_pk_bf16_f32 v76, v216, v217
    v_cvt_pk_bf16_f32 v77, v218, v219
    v_cvt_pk_bf16_f32 v78, v220, v221
    v_cvt_pk_bf16_f32 v79, v222, v223
    v_mfma_f32_32x32x16_bf16 v[192:207], v[60:63], a[20:23], v[192:207]
    ds_read_b64_tr_b16 a[144:145], v16 offset:8192
    ds_read_b64_tr_b16 a[146:147], v16 offset:8704
    ds_read_b64_tr_b16 a[148:149], v17 offset:8192
    ds_read_b64_tr_b16 a[150:151], v17 offset:8704
    v_mfma_f32_32x32x16_bf16 v[224:239], a[160:163], v[72:75], v[224:239]
    ds_read_b32 v52, v19 offset:384
    s_add_u32 s56, s58, 861184
    s_add_u32 m0, s59, 35840
    s_nop 0
    buffer_load_dwordx4 v10, s[16:19], s56 offen lds
    s_add_u32 s56, s35, 768
    v_mfma_f32_32x32x16_bf16 a[128:143], v[72:75], a[164:167], a[128:143]
    ds_read_b64_tr_b16 a[152:153], v16 offset:10240
    ds_read_b64_tr_b16 a[154:155], v16 offset:10752
    ds_read_b64_tr_b16 a[156:157], v17 offset:10240
    ds_read_b64_tr_b16 a[158:159], v17 offset:10752
    s_waitcnt lgkmcnt(9)
    v_mfma_f32_32x32x16_bf16 v[224:239], a[168:171], v[76:79], v[224:239]
    s_add_u32 m0, s64, 32768
    s_nop 0
    buffer_load_dwordx4 v20, s[12:15], s56 offen lds
    s_add_u32 s56, s35, 4864
    s_add_u32 m0, s64, 33792
    s_nop 0
    buffer_load_dwordx4 v21, s[12:15], s56 offen lds
    v_mfma_f32_32x32x16_bf16 a[128:143], v[76:79], a[172:175], a[128:143]
    s_waitcnt lgkmcnt(4)
    v_perm_b32 v2, v52, v52, s7
    v_and_b32 v56, v2, v40
    v_and_b32 v57, v2, v41
    v_and_b32 v58, v2, v42
    v_and_b32 v59, v2, v43
    v_and_b32 v60, v2, v44
    v_and_b32 v61, v2, v45
    v_and_b32 v62, v2, v46
    v_and_b32 v63, v2, v47
    v_mfma_f32_32x32x16_bf16 v[208:223], v[52:55], v[28:31], 0
    v_cvt_pk_bf16_f32 v80, v192, v193
    v_cvt_pk_bf16_f32 v81, v194, v195
    v_cvt_pk_bf16_f32 v82, v196, v197
    v_cvt_pk_bf16_f32 v83, v198, v199
    v_mfma_f32_32x32x16_bf16 v[208:223], v[56:59], a[24:27], v[208:223]
    v_cvt_pk_bf16_f32 v84, v200, v201
    v_cvt_pk_bf16_f32 v85, v202, v203
    v_cvt_pk_bf16_f32 v86, v204, v205
    v_cvt_pk_bf16_f32 v87, v206, v207
    v_mfma_f32_32x32x16_bf16 v[208:223], v[60:63], a[28:31], v[208:223]
    ds_read_b64_tr_b16 a[160:161], v16 offset:12288
    ds_read_b64_tr_b16 a[162:163], v16 offset:12800
    ds_read_b64_tr_b16 a[164:165], v17 offset:12288
    ds_read_b64_tr_b16 a[166:167], v17 offset:12800
    v_mfma_f32_32x32x16_bf16 v[224:239], a[144:147], v[80:83], v[224:239]
    ds_read_b32 v48, v19 offset:512
    s_add_u32 s56, s35, 8960
    s_add_u32 m0, s64, 34816
    s_nop 0
    buffer_load_dwordx4 v22, s[12:15], s56 offen lds
    s_add_u32 s56, s35, 13056
    v_mfma_f32_32x32x16_bf16 a[128:143], v[80:83], a[148:151], a[128:143]
    ds_read_b64_tr_b16 a[168:169], v16 offset:14336
    ds_read_b64_tr_b16 a[170:171], v16 offset:14848
    ds_read_b64_tr_b16 a[172:173], v17 offset:14336
    ds_read_b64_tr_b16 a[174:175], v17 offset:14848
    s_waitcnt lgkmcnt(9)
    v_mfma_f32_32x32x16_bf16 v[224:239], a[152:155], v[84:87], v[224:239]
    s_add_u32 m0, s64, 35840
    s_nop 0
    buffer_load_dwordx4 v23, s[12:15], s56 offen lds
    s_add_u32 s56, s35, 17152
    s_add_u32 m0, s64, 36864
    s_nop 0
    buffer_load_dwordx4 v20, s[12:15], s56 offen lds
    v_mfma_f32_32x32x16_bf16 a[128:143], v[84:87], a[156:159], a[128:143]
    s_waitcnt lgkmcnt(4)
    v_perm_b32 v2, v48, v48, s7
    v_and_b32 v56, v2, v40
    v_and_b32 v57, v2, v41
    v_and_b32 v58, v2, v42
    v_and_b32 v59, v2, v43
    v_and_b32 v60, v2, v44
    v_and_b32 v61, v2, v45
    v_and_b32 v62, v2, v46
    v_and_b32 v63, v2, v47
    v_mfma_f32_32x32x16_bf16 v[192:207], v[48:51], v[28:31], 0
    v_cvt_pk_bf16_f32 v88, v208, v209
    v_cvt_pk_bf16_f32 v89, v210, v211
    v_cvt_pk_bf16_f32 v90, v212, v213
    v_cvt_pk_bf16_f32 v91, v214, v215
    v_mfma_f32_32x32x16_bf16 v[192:207], v[56:59], a[32:35], v[192:207]
    v_cvt_pk_bf16_f32 v92, v216, v217
    v_cvt_pk_bf16_f32 v93, v218, v219
    v_cvt_pk_bf16_f32 v94, v220, v221
    v_cvt_pk_bf16_f32 v95, v222, v223
    v_mfma_f32_32x32x16_bf16 v[192:207], v[60:63], a[36:39], v[192:207]
    ds_read_b64_tr_b16 a[144:145], v16 offset:16384
    ds_read_b64_tr_b16 a[146:147], v16 offset:16896
    ds_read_b64_tr_b16 a[148:149], v17 offset:16384
    ds_read_b64_tr_b16 a[150:151], v17 offset:16896
    v_mfma_f32_32x32x16_bf16 v[224:239], a[160:163], v[88:91], v[224:239]
    ds_read_b32 v52, v19 offset:640
    s_add_u32 s56, s35, 21248
    s_add_u32 m0, s64, 37888
    s_nop 0
    buffer_load_dwordx4 v21, s[12:15], s56 offen lds
    s_add_u32 s56, s35, 25344
    v_mfma_f32_32x32x16_bf16 a[128:143], v[88:91], a[164:167], a[128:143]
    ds_read_b64_tr_b16 a[152:153], v16 offset:18432
    ds_read_b64_tr_b16 a[154:155], v16 offset:18944
    ds_read_b64_tr_b16 a[156:157], v17 offset:18432
    ds_read_b64_tr_b16 a[158:159], v17 offset:18944
    s_waitcnt lgkmcnt(9)
    v_mfma_f32_32x32x16_bf16 v[224:239], a[168:171], v[92:95], v[224:239]
    s_add_u32 m0, s64, 38912
    s_nop 0
    buffer_load_dwordx4 v22, s[12:15], s56 offen lds
    s_add_u32 s56, s35, 29440
    s_add_u32 m0, s64, 39936
    s_nop 0
    buffer_load_dwordx4 v23, s[12:15], s56 offen lds
    v_mfma_f32_32x32x16_bf16 a[128:143], v[92:95], a[172:175], a[128:143]
    s_waitcnt lgkmcnt(4)
    v_perm_b32 v2, v52, v52, s7
    v_and_b32 v56, v2, v40
    v_and_b32 v57, v2, v41
    v_and_b32 v58, v2, v42
    v_and_b32 v59, v2, v43
    v_and_b32 v60, v2, v44
    v_and_b32 v61, v2, v45
    v_and_b32 v62, v2, v46
    v_and_b32 v63, v2, v47
    v_mfma_f32_32x32x16_bf16 v[208:223], v[52:55], v[28:31], 0
    v_cvt_pk_bf16_f32 v96, v192, v193
    v_cvt_pk_bf16_f32 v97, v194, v195
    v_cvt_pk_bf16_f32 v98, v196, v197
    v_cvt_pk_bf16_f32 v99, v198, v199
    v_mfma_f32_32x32x16_bf16 v[208:223], v[56:59], a[40:43], v[208:223]
    v_cvt_pk_bf16_f32 v100, v200, v201
    v_cvt_pk_bf16_f32 v101, v202, v203
    v_cvt_pk_bf16_f32 v102, v204, v205
    v_cvt_pk_bf16_f32 v103, v206, v207
    v_mfma_f32_32x32x16_bf16 v[208:223], v[60:63], a[44:47], v[208:223]
    ds_read_b64_tr_b16 a[160:161], v16 offset:20480
    ds_read_b64_tr_b16 a[162:163], v16 offset:20992
    ds_read_b64_tr_b16 a[164:165], v17 offset:20480
    ds_read_b64_tr_b16 a[166:167], v17 offset:20992
    v_mfma_f32_32x32x16_bf16 v[224:239], a[144:147], v[96:99], v[224:239]
    ds_read_b32 v48, v19 offset:768
    s_add_u32 s56, s58, 1180672
    s_add_u32 m0, s59, 49152
    s_nop 0
    buffer_load_dwordx4 v10, s[16:19], s56 offen lds
    s_add_u32 s56, s58, 1205248
    v_mfma_f32_32x32x16_bf16 a[128:143], v[96:99], a[148:151], a[128:143]
    ds_read_b64_tr_b16 a[168:169], v16 offset:22528
    ds_read_b64_tr_b16 a[170:171], v16 offset:23040
    ds_read_b64_tr_b16 a[172:173], v17 offset:22528
    ds_read_b64_tr_b16 a[174:175], v17 offset:23040
    s_waitcnt lgkmcnt(9)
    v_mfma_f32_32x32x16_bf16 v[224:239], a[152:155], v[100:103], v[224:239]
    s_add_u32 m0, s59, 50176
    s_nop 0
    buffer_load_dwordx4 v10, s[16:19], s56 offen lds
    s_add_u32 s56, s58, 1229824
    s_add_u32 m0, s59, 51200
    s_nop 0
    buffer_load_dwordx4 v10, s[16:19], s56 offen lds
    v_mfma_f32_32x32x16_bf16 a[128:143], v[100:103], a[156:159], a[128:143]
    s_waitcnt lgkmcnt(4)
    v_perm_b32 v2, v48, v48, s7
    v_and_b32 v56, v2, v40
    v_and_b32 v57, v2, v41
    v_and_b32 v58, v2, v42
    v_and_b32 v59, v2, v43
    v_and_b32 v60, v2, v44
    v_and_b32 v61, v2, v45
    v_and_b32 v62, v2, v46
    v_and_b32 v63, v2, v47
    v_mfma_f32_32x32x16_bf16 v[192:207], v[48:51], v[28:31], 0
    v_cvt_pk_bf16_f32 v104, v208, v209
    v_cvt_pk_bf16_f32 v105, v210, v211
    v_cvt_pk_bf16_f32 v106, v212, v213
    v_cvt_pk_bf16_f32 v107, v214, v215
    v_mfma_f32_32x32x16_bf16 v[192:207], v[56:59], a[48:51], v[192:207]
    v_cvt_pk_bf16_f32 v108, v216, v217
    v_cvt_pk_bf16_f32 v109, v218, v219
    v_cvt_pk_bf16_f32 v110, v220, v221
    v_cvt_pk_bf16_f32 v111, v222, v223
    v_mfma_f32_32x32x16_bf16 v[192:207], v[60:63], a[52:55], v[192:207]
    ds_read_b64_tr_b16 a[144:145], v16 offset:24576
    ds_read_b64_tr_b16 a[146:147], v16 offset:25088
    ds_read_b64_tr_b16 a[148:149], v17 offset:24576
    ds_read_b64_tr_b16 a[150:151], v17 offset:25088
    v_mfma_f32_32x32x16_bf16 v[224:239], a[160:163], v[104:107], v[224:239]
    ds_read_b32 v52, v19 offset:896
    s_add_u32 s56, s58, 1254400
    s_add_u32 m0, s59, 52224
    s_nop 0
    buffer_load_dwordx4 v10, s[16:19], s56 offen lds
    s_waitcnt vmcnt(16)
    v_mfma_f32_32x32x16_bf16 a[128:143], v[104:107], a[164:167], a[128:143]
    ds_read_b64_tr_b16 a[152:153], v16 offset:26624
    ds_read_b64_tr_b16 a[154:155], v16 offset:27136
    ds_read_b64_tr_b16 a[156:157], v17 offset:26624
    ds_read_b64_tr_b16 a[158:159], v17 offset:27136
    s_waitcnt lgkmcnt(9)
    v_mfma_f32_32x32x16_bf16 v[224:239], a[168:171], v[108:111], v[224:239]
    ds_read_b128 a[64:67], v32 offset:0
    ds_read_b128 a[68:71], v33 offset:0
    ds_read_b128 a[72:75], v34 offset:0
    ds_read_b128 a[76:79], v35 offset:0
    ds_read_b128 a[80:83], v36 offset:0
    v_mfma_f32_32x32x16_bf16 a[128:143], v[108:111], a[172:175], a[128:143]
    s_waitcnt lgkmcnt(9)
    v_perm_b32 v2, v52, v52, s7
    v_and_b32 v56, v2, v40
    v_and_b32 v57, v2, v41
    v_and_b32 v58, v2, v42
    v_and_b32 v59, v2, v43
    v_and_b32 v60, v2, v44
    v_and_b32 v61, v2, v45
    v_and_b32 v62, v2, v46
    v_and_b32 v63, v2, v47
    v_mfma_f32_32x32x16_bf16 v[208:223], v[52:55], v[28:31], 0
    v_cvt_pk_bf16_f32 v112, v192, v193
    v_cvt_pk_bf16_f32 v113, v194, v195
    v_cvt_pk_bf16_f32 v114, v196, v197
    v_cvt_pk_bf16_f32 v115, v198, v199
    v_mfma_f32_32x32x16_bf16 v[208:223], v[56:59], a[56:59], v[208:223]
    v_cvt_pk_bf16_f32 v116, v200, v201
    v_cvt_pk_bf16_f32 v117, v202, v203
    v_cvt_pk_bf16_f32 v118, v204, v205
    v_cvt_pk_bf16_f32 v119, v206, v207
    v_mfma_f32_32x32x16_bf16 v[208:223], v[60:63], a[60:63], v[208:223]
    ds_read_b64_tr_b16 a[160:161], v16 offset:28672
    ds_read_b64_tr_b16 a[162:163], v16 offset:29184
    ds_read_b64_tr_b16 a[164:165], v17 offset:28672
    ds_read_b64_tr_b16 a[166:167], v17 offset:29184
    v_mfma_f32_32x32x16_bf16 v[224:239], a[144:147], v[112:115], v[224:239]
    ds_read_b32 v48, v19 offset:1024
    ds_read_b128 a[84:87], v37 offset:0
    ds_read_b128 a[88:91], v38 offset:0
    ds_read_b128 a[92:95], v39 offset:0
    buffer_store_dwordx4 v[248:251], v3, s[24:27], s93 offen offset:0 sc1
    v_mfma_f32_32x32x16_bf16 a[128:143], v[112:115], a[148:151], a[128:143]
    ds_read_b64_tr_b16 a[168:169], v16 offset:30720
    ds_read_b64_tr_b16 a[170:171], v16 offset:31232
    ds_read_b64_tr_b16 a[172:173], v17 offset:30720
    ds_read_b64_tr_b16 a[174:175], v17 offset:31232
    s_waitcnt lgkmcnt(15)
    v_mfma_f32_32x32x16_bf16 v[224:239], a[152:155], v[116:119], v[224:239]
    buffer_store_dwordx4 v[248:251], v3, s[24:27], s93 offen offset:1024 sc1
    ds_read_b64_tr_b16 v[240:241], v9
    ds_read_b64_tr_b16 v[242:243], v9 offset:128
    s_waitcnt lgkmcnt(0)
    v_and_b32 v13, 4, v1
    v_mfma_f32_32x32x16_bf16 a[128:143], v[116:119], a[156:159], a[128:143]
    s_waitcnt lgkmcnt(0)
    v_perm_b32 v2, v48, v48, s7
    v_and_b32 v56, v2, v40
    v_and_b32 v57, v2, v41
    v_and_b32 v58, v2, v42
    v_and_b32 v59, v2, v43
    v_and_b32 v60, v2, v44
    v_and_b32 v61, v2, v45
    v_and_b32 v62, v2, v46
    v_and_b32 v63, v2, v47
    v_mfma_f32_32x32x16_bf16 v[192:207], v[48:51], v[28:31], 0
    v_cvt_pk_bf16_f32 v120, v208, v209
    v_cvt_pk_bf16_f32 v121, v210, v211
    v_cvt_pk_bf16_f32 v122, v212, v213
    v_cvt_pk_bf16_f32 v123, v214, v215
    v_mfma_f32_32x32x16_bf16 v[192:207], v[56:59], a[64:67], v[192:207]
    v_cvt_pk_bf16_f32 v124, v216, v217
    v_cvt_pk_bf16_f32 v125, v218, v219
    v_cvt_pk_bf16_f32 v126, v220, v221
    v_cvt_pk_bf16_f32 v127, v222, v223
    v_mfma_f32_32x32x16_bf16 v[192:207], v[60:63], a[68:71], v[192:207]
    s_waitcnt vmcnt(2)
    s_waitcnt lgkmcnt(0)
    s_barrier
    ds_read_b64_tr_b16 a[144:145], v16 offset:32768
    ds_read_b64_tr_b16 a[146:147], v16 offset:33280
    ds_read_b64_tr_b16 a[148:149], v17 offset:32768
    ds_read_b64_tr_b16 a[150:151], v17 offset:33280
    v_mfma_f32_32x32x16_bf16 v[224:239], a[160:163], v[120:123], v[224:239]
    ds_read_b32 v52, v19 offset:1152
    ds_read_b128 a[96:99], v32 offset:32768
    ds_read_b128 a[100:103], v33 offset:32768
    ds_read_b128 a[104:107], v34 offset:32768
    v_mfma_f32_32x32x16_bf16 a[128:143], v[120:123], a[164:167], a[128:143]
    ds_read_b64_tr_b16 a[152:153], v16 offset:34816
    ds_read_b64_tr_b16 a[154:155], v16 offset:35328
    ds_read_b64_tr_b16 a[156:157], v17 offset:34816
    ds_read_b64_tr_b16 a[158:159], v17 offset:35328
    v_mfma_f32_32x32x16_bf16 v[224:239], a[168:171], v[124:127], v[224:239]
    ds_read_b128 a[108:111], v35 offset:32768
    ds_read_b128 a[112:115], v36 offset:32768
    ds_read_b128 a[116:119], v37 offset:32768
    ds_read_b128 a[120:123], v38 offset:32768
    ds_read_b128 a[124:127], v39 offset:32768
    v_mfma_f32_32x32x16_bf16 a[128:143], v[124:127], a[172:175], a[128:143]
    s_waitcnt lgkmcnt(12)
    v_perm_b32 v2, v52, v52, s7
    v_and_b32 v56, v2, v40
    v_and_b32 v57, v2, v41
    v_and_b32 v58, v2, v42
    v_and_b32 v59, v2, v43
    v_and_b32 v60, v2, v44
    v_and_b32 v61, v2, v45
    v_and_b32 v62, v2, v46
    v_and_b32 v63, v2, v47
    v_mfma_f32_32x32x16_bf16 v[208:223], v[52:55], v[28:31], 0
    v_cvt_pk_bf16_f32 v128, v192, v193
    v_cvt_pk_bf16_f32 v129, v194, v195
    v_cvt_pk_bf16_f32 v130, v196, v197
    v_cvt_pk_bf16_f32 v131, v198, v199
    v_mfma_f32_32x32x16_bf16 v[208:223], v[56:59], a[72:75], v[208:223]
    v_cvt_pk_bf16_f32 v132, v200, v201
    v_cvt_pk_bf16_f32 v133, v202, v203
    v_cvt_pk_bf16_f32 v134, v204, v205
    v_cvt_pk_bf16_f32 v135, v206, v207
    v_mfma_f32_32x32x16_bf16 v[208:223], v[60:63], a[76:79], v[208:223]
    ds_read_b64_tr_b16 a[160:161], v16 offset:36864
    ds_read_b64_tr_b16 a[162:163], v16 offset:37376
    ds_read_b64_tr_b16 a[164:165], v17 offset:36864
    ds_read_b64_tr_b16 a[166:167], v17 offset:37376
    v_mfma_f32_32x32x16_bf16 v[224:239], a[144:147], v[128:131], v[224:239]
    ds_read_b32 v48, v19 offset:1280
    s_lshl_b32 s59, s30, 11
    s_add_u32 s56, s58, 0
    s_add_u32 m0, s59, 0
    s_nop 0
    buffer_load_dwordx4 v11, s[16:19], s56 offen lds
    v_mfma_f32_32x32x16_bf16 a[128:143], v[128:131], a[148:151], a[128:143]
    ds_read_b64_tr_b16 a[168:169], v16 offset:38912
    ds_read_b64_tr_b16 a[170:171], v16 offset:39424
    ds_read_b64_tr_b16 a[172:173], v17 offset:38912
    ds_read_b64_tr_b16 a[174:175], v17 offset:39424
    s_waitcnt lgkmcnt(14)
    v_mfma_f32_32x32x16_bf16 v[224:239], a[152:155], v[132:135], v[224:239]
    s_add_u32 s56, s58, 49152
    s_add_u32 m0, s59, 1024
    s_nop 0
    buffer_load_dwordx4 v11, s[16:19], s56 offen lds
    s_add_u32 s56, s58, 393216
    s_add_u32 m0, s59, 8192
    v_mfma_f32_32x32x16_bf16 a[128:143], v[132:135], a[156:159], a[128:143]
    s_waitcnt lgkmcnt(4)
    v_perm_b32 v2, v48, v48, s7
    v_and_b32 v56, v2, v40
    v_and_b32 v57, v2, v41
    v_and_b32 v58, v2, v42
    v_and_b32 v59, v2, v43
    v_and_b32 v60, v2, v44
    v_and_b32 v61, v2, v45
    v_and_b32 v62, v2, v46
    v_and_b32 v63, v2, v47
    v_mfma_f32_32x32x16_bf16 v[192:207], v[48:51], v[28:31], 0
    v_cvt_pk_bf16_f32 v136, v208, v209
    v_cvt_pk_bf16_f32 v137, v210, v211
    v_cvt_pk_bf16_f32 v138, v212, v213
    v_cvt_pk_bf16_f32 v139, v214, v215
    v_mfma_f32_32x32x16_bf16 v[192:207], v[56:59], a[80:83], v[192:207]
    v_cvt_pk_bf16_f32 v140, v216, v217
    v_cvt_pk_bf16_f32 v141, v218, v219
    v_cvt_pk_bf16_f32 v142, v220, v221
    v_cvt_pk_bf16_f32 v143, v222, v223
    v_mfma_f32_32x32x16_bf16 v[192:207], v[60:63], a[84:87], v[192:207]
    ds_read_b64_tr_b16 a[144:145], v16 offset:40960
    ds_read_b64_tr_b16 a[146:147], v16 offset:41472
    ds_read_b64_tr_b16 a[148:149], v17 offset:40960
    ds_read_b64_tr_b16 a[150:151], v17 offset:41472
    v_mfma_f32_32x32x16_bf16 v[224:239], a[160:163], v[136:139], v[224:239]
    ds_read_b32 v52, v19 offset:1408
    buffer_load_dwordx4 v11, s[16:19], s56 offen lds
    s_add_u32 s56, s58, 442368
    s_add_u32 m0, s59, 9216
    s_nop 0
    buffer_load_dwordx4 v11, s[16:19], s56 offen lds
    v_mfma_f32_32x32x16_bf16 a[128:143], v[136:139], a[164:167], a[128:143]
    ds_read_b64_tr_b16 a[152:153], v16 offset:43008
    ds_read_b64_tr_b16 a[154:155], v16 offset:43520
    ds_read_b64_tr_b16 a[156:157], v17 offset:43008
    ds_read_b64_tr_b16 a[158:159], v17 offset:43520
    s_waitcnt lgkmcnt(9)
    v_mfma_f32_32x32x16_bf16 v[224:239], a[168:171], v[140:143], v[224:239]
    s_add_u32 s56, s58, 786432
    s_add_u32 m0, s59, 16384
    s_nop 0
    buffer_load_dwordx4 v11, s[16:19], s56 offen lds
    s_add_u32 s56, s58, 835584
    s_add_u32 m0, s59, 17408
    v_mfma_f32_32x32x16_bf16 a[128:143], v[140:143], a[172:175], a[128:143]
    s_waitcnt lgkmcnt(4)
    v_perm_b32 v2, v52, v52, s7
    v_and_b32 v56, v2, v40
    v_and_b32 v57, v2, v41
    v_and_b32 v58, v2, v42
    v_and_b32 v59, v2, v43
    v_and_b32 v60, v2, v44
    v_and_b32 v61, v2, v45
    v_and_b32 v62, v2, v46
    v_and_b32 v63, v2, v47
    v_mfma_f32_32x32x16_bf16 v[208:223], v[52:55], v[28:31], 0
    v_cvt_pk_bf16_f32 v144, v192, v193
    v_cvt_pk_bf16_f32 v145, v194, v195
    v_cvt_pk_bf16_f32 v146, v196, v197
    v_cvt_pk_bf16_f32 v147, v198, v199
    v_mfma_f32_32x32x16_bf16 v[208:223], v[56:59], a[88:91], v[208:223]
    v_cvt_pk_bf16_f32 v148, v200, v201
    v_cvt_pk_bf16_f32 v149, v202, v203
    v_cvt_pk_bf16_f32 v150, v204, v205
    v_cvt_pk_bf16_f32 v151, v206, v207
    v_mfma_f32_32x32x16_bf16 v[208:223], v[60:63], a[92:95], v[208:223]
    ds_read_b64_tr_b16 a[160:161], v16 offset:45056
    ds_read_b64_tr_b16 a[162:163], v16 offset:45568
    ds_read_b64_tr_b16 a[164:165], v17 offset:45056
    ds_read_b64_tr_b16 a[166:167], v17 offset:45568
    v_mfma_f32_32x32x16_bf16 v[224:239], a[144:147], v[144:147], v[224:239]
    ds_read_b32 v48, v19 offset:1536
    buffer_load_dwordx4 v11, s[16:19], s56 offen lds
    s_add_u32 s56, s58, 1179648
    s_add_u32 m0, s59, 24576
    s_nop 0
    buffer_load_dwordx4 v11, s[16:19], s56 offen lds
    v_mfma_f32_32x32x16_bf16 a[128:143], v[144:147], a[148:151], a[128:143]
    ds_read_b64_tr_b16 a[168:169], v16 offset:47104
    ds_read_b64_tr_b16 a[170:171], v16 offset:47616
    ds_read_b64_tr_b16 a[172:173], v17 offset:47104
    ds_read_b64_tr_b16 a[174:175], v17 offset:47616
    s_waitcnt lgkmcnt(9)
    v_mfma_f32_32x32x16_bf16 v[224:239], a[152:155], v[148:151], v[224:239]
    s_add_u32 s56, s58, 1228800
    s_add_u32 m0, s59, 25600
    s_nop 0
    buffer_load_dwordx4 v11, s[16:19], s56 offen lds
    v_cmp_eq_u32 vcc, 0, v13
    s_nop 1
    v_cndmask_b32 v244, v240, 0, vcc
    v_mfma_f32_32x32x16_bf16 a[128:143], v[148:151], a[156:159], a[128:143]
    s_waitcnt lgkmcnt(0)
    v_perm_b32 v2, v48, v48, s7
    v_and_b32 v56, v2, v40
    v_and_b32 v57, v2, v41
    v_and_b32 v58, v2, v42
    v_and_b32 v59, v2, v43
    v_and_b32 v60, v2, v44
    v_and_b32 v61, v2, v45
    v_and_b32 v62, v2, v46
    v_and_b32 v63, v2, v47
    v_mfma_f32_32x32x16_bf16 v[192:207], v[48:51], v[28:31], 0
    v_cvt_pk_bf16_f32 v152, v208, v209
    v_cvt_pk_bf16_f32 v153, v210, v211
    v_cvt_pk_bf16_f32 v154, v212, v213
    v_cvt_pk_bf16_f32 v155, v214, v215
    v_mfma_f32_32x32x16_bf16 v[192:207], v[56:59], a[96:99], v[192:207]
    v_cvt_pk_bf16_f32 v156, v216, v217
    v_cvt_pk_bf16_f32 v157, v218, v219
    v_cvt_pk_bf16_f32 v158, v220, v221
    v_cvt_pk_bf16_f32 v159, v222, v223
    v_mfma_f32_32x32x16_bf16 v[192:207], v[60:63], a[100:103], v[192:207]
    ds_read_b64_tr_b16 a[144:145], v16 offset:49152
    ds_read_b64_tr_b16 a[146:147], v16 offset:49664
    ds_read_b64_tr_b16 a[148:149], v17 offset:49152
    ds_read_b64_tr_b16 a[150:151], v17 offset:49664
    v_mfma_f32_32x32x16_bf16 v[224:239], a[160:163], v[152:155], v[224:239]
    ds_read_b32 v52, v19 offset:1664
    v_cndmask_b32 v245, v241, 0, vcc
    v_cndmask_b32 v246, v242, 0, vcc
    v_cndmask_b32 v247, v243, 0, vcc
    v_cndmask_b32 v240, 0, v240, vcc
    v_mfma_f32_32x32x16_bf16 a[128:143], v[152:155], a[164:167], a[128:143]
    ds_read_b64_tr_b16 a[152:153], v16 offset:51200
    ds_read_b64_tr_b16 a[154:155], v16 offset:51712
    ds_read_b64_tr_b16 a[156:157], v17 offset:51200
    ds_read_b64_tr_b16 a[158:159], v17 offset:51712
    v_mfma_f32_32x32x16_bf16 v[224:239], a[168:171], v[156:159], v[224:239]
    v_cndmask_b32 v241, 0, v241, vcc
    v_cndmask_b32 v242, 0, v242, vcc
    v_cndmask_b32 v243, 0, v243, vcc
    s_lshl_b32 s5, s30, 11
    s_add_u32 s5, s5, 151552
    v_mfma_f32_32x32x16_bf16 a[128:143], v[156:159], a[172:175], a[128:143]
    s_waitcnt lgkmcnt(4)
    v_perm_b32 v2, v52, v52, s7
    v_and_b32 v56, v2, v40
    v_and_b32 v57, v2, v41
    v_and_b32 v58, v2, v42
    v_and_b32 v59, v2, v43
    v_and_b32 v60, v2, v44
    v_and_b32 v61, v2, v45
    v_and_b32 v62, v2, v46
    v_and_b32 v63, v2, v47
    v_mfma_f32_32x32x16_bf16 v[208:223], v[52:55], v[28:31], 0
    v_cvt_pk_bf16_f32 v160, v192, v193
    v_cvt_pk_bf16_f32 v161, v194, v195
    v_cvt_pk_bf16_f32 v162, v196, v197
    v_cvt_pk_bf16_f32 v163, v198, v199
    v_mfma_f32_32x32x16_bf16 v[208:223], v[56:59], a[104:107], v[208:223]
    v_cvt_pk_bf16_f32 v164, v200, v201
    v_cvt_pk_bf16_f32 v165, v202, v203
    v_cvt_pk_bf16_f32 v166, v204, v205
    v_cvt_pk_bf16_f32 v167, v206, v207
    v_mfma_f32_32x32x16_bf16 v[208:223], v[60:63], a[108:111], v[208:223]
    ds_read_b64_tr_b16 a[160:161], v16 offset:53248
    ds_read_b64_tr_b16 a[162:163], v16 offset:53760
    ds_read_b64_tr_b16 a[164:165], v17 offset:53248
    ds_read_b64_tr_b16 a[166:167], v17 offset:53760
    v_mfma_f32_32x32x16_bf16 v[224:239], a[144:147], v[160:163], v[224:239]
    ds_read_b32 v48, v19 offset:1792
    v_add_u32 v20, s5, v3
    v_and_b32 v13, 31, v1
    v_mul_u32_u24 v13, 80, v13
    v_mul_u32_u24 v14, 2560, v6
    v_mfma_f32_32x32x16_bf16 a[128:143], v[160:163], a[148:151], a[128:143]
    ds_read_b64_tr_b16 a[168:169], v16 offset:55296
    ds_read_b64_tr_b16 a[170:171], v16 offset:55808
    ds_read_b64_tr_b16 a[172:173], v17 offset:55296
    ds_read_b64_tr_b16 a[174:175], v17 offset:55808
    s_waitcnt lgkmcnt(9)
    v_mfma_f32_32x32x16_bf16 v[224:239], a[152:155], v[164:167], v[224:239]
    s_mul_i32 s5, s30, 5120
    s_add_u32 s5, s5, 131072
    v_add3_u32 v21, v13, v14, s5
    v_and_b32 v13, 0x2f, v1
    v_lshlrev_b32 v13, 4, v13
    v_mfma_f32_32x32x16_bf16 a[128:143], v[164:167], a[156:159], a[128:143]
    s_waitcnt lgkmcnt(4)
    v_perm_b32 v2, v48, v48, s7
    v_and_b32 v56, v2, v40
    v_and_b32 v57, v2, v41
    v_and_b32 v58, v2, v42
    v_and_b32 v59, v2, v43
    v_and_b32 v60, v2, v44
    v_and_b32 v61, v2, v45
    v_and_b32 v62, v2, v46
    v_and_b32 v63, v2, v47
    v_mfma_f32_32x32x16_bf16 v[192:207], v[48:51], v[28:31], 0
    v_cvt_pk_bf16_f32 v168, v208, v209
    v_cvt_pk_bf16_f32 v169, v210, v211
    v_cvt_pk_bf16_f32 v170, v212, v213
    v_cvt_pk_bf16_f32 v171, v214, v215
    v_mfma_f32_32x32x16_bf16 v[192:207], v[56:59], a[112:115], v[192:207]
    v_cvt_pk_bf16_f32 v172, v216, v217
    v_cvt_pk_bf16_f32 v173, v218, v219
    v_cvt_pk_bf16_f32 v174, v220, v221
    v_cvt_pk_bf16_f32 v175, v222, v223
    v_mfma_f32_32x32x16_bf16 v[192:207], v[60:63], a[116:119], v[192:207]
    ds_read_b64_tr_b16 a[144:145], v16 offset:57344
    ds_read_b64_tr_b16 a[146:147], v16 offset:57856
    ds_read_b64_tr_b16 a[148:149], v17 offset:57344
    ds_read_b64_tr_b16 a[150:151], v17 offset:57856
    v_mfma_f32_32x32x16_bf16 v[224:239], a[160:163], v[168:171], v[224:239]
    ds_read_b32 v52, v19 offset:1920
    s_lshl_b32 s5, s33, 8
    s_add_u32 s5, s5, 151552
    v_add_u32 v22, s5, v13
    v_bfe_u32 v15, v1, 2, 2
    v_mfma_f32_32x32x16_bf16 a[128:143], v[168:171], a[164:167], a[128:143]
    ds_read_b64_tr_b16 a[152:153], v16 offset:59392
    ds_read_b64_tr_b16 a[154:155], v16 offset:59904
    ds_read_b64_tr_b16 a[156:157], v17 offset:59392
    ds_read_b64_tr_b16 a[158:159], v17 offset:59904
    s_waitcnt lgkmcnt(9)
    v_mfma_f32_32x32x16_bf16 v[224:239], a[168:171], v[172:175], v[224:239]
    v_lshl_add_u32 v14, v6, 2, v15
    v_mul_u32_u24 v14, 80, v14
    s_mul_i32 s5, s33, 2560
    s_add_u32 s5, s5, 131072
    v_add3_u32 v23, v14, v5, s5
    v_mfma_f32_32x32x16_bf16 a[128:143], v[172:175], a[172:175], a[128:143]
    s_waitcnt lgkmcnt(4)
    v_perm_b32 v2, v52, v52, s7
    v_and_b32 v56, v2, v40
    v_and_b32 v57, v2, v41
    v_and_b32 v58, v2, v42
    v_and_b32 v59, v2, v43
    v_and_b32 v60, v2, v44
    v_and_b32 v61, v2, v45
    v_and_b32 v62, v2, v46
    v_and_b32 v63, v2, v47
    v_mfma_f32_32x32x16_bf16 v[208:223], v[52:55], v[28:31], 0
    v_cvt_pk_bf16_f32 v176, v192, v193
    v_cvt_pk_bf16_f32 v177, v194, v195
    v_cvt_pk_bf16_f32 v178, v196, v197
    v_cvt_pk_bf16_f32 v179, v198, v199
    v_mfma_f32_32x32x16_bf16 v[208:223], v[56:59], a[120:123], v[208:223]
    v_cvt_pk_bf16_f32 v180, v200, v201
    v_cvt_pk_bf16_f32 v181, v202, v203
    v_cvt_pk_bf16_f32 v182, v204, v205
    v_cvt_pk_bf16_f32 v183, v206, v207
    v_mfma_f32_32x32x16_bf16 v[208:223], v[60:63], a[124:127], v[208:223]
    ds_read_b64_tr_b16 a[160:161], v16 offset:61440
    ds_read_b64_tr_b16 a[162:163], v16 offset:61952
    ds_read_b64_tr_b16 a[164:165], v17 offset:61440
    ds_read_b64_tr_b16 a[166:167], v17 offset:61952
    v_mfma_f32_32x32x16_bf16 v[224:239], a[144:147], v[176:179], v[224:239]
    v_mov_b32 v7, 0x3f803f80
    s_mov_b32 s8, 0x3fb8aa3b
    s_mov_b32 s9, 0x3fb8aa3b
    s_mul_i32 s10, s29, 21846
    v_mfma_f32_32x32x16_bf16 a[128:143], v[176:179], a[148:151], a[128:143]
    ds_read_b64_tr_b16 a[168:169], v16 offset:63488
    ds_read_b64_tr_b16 a[170:171], v16 offset:64000
    ds_read_b64_tr_b16 a[172:173], v17 offset:63488
    ds_read_b64_tr_b16 a[174:175], v17 offset:64000
    s_waitcnt lgkmcnt(8)
    v_mfma_f32_32x32x16_bf16 v[224:239], a[152:155], v[180:183], v[224:239]
    s_lshr_b32 s10, s10, 16
    s_lshl_b32 s10, s10, 1
    s_mul_i32 s4, s29, 6
    s_sub_u32 s10, s4, s10
    s_lshl_b32 s4, s28, 2
    v_mfma_f32_32x32x16_bf16 a[128:143], v[180:183], a[156:159], a[128:143]
    v_cvt_pk_bf16_f32 v184, v208, v209
    v_cvt_pk_bf16_f32 v185, v210, v211
    v_cvt_pk_bf16_f32 v186, v212, v213
    v_cvt_pk_bf16_f32 v187, v214, v215
    v_cvt_pk_bf16_f32 v188, v216, v217
    v_cvt_pk_bf16_f32 v189, v218, v219
    v_cvt_pk_bf16_f32 v190, v220, v221
    v_cvt_pk_bf16_f32 v191, v222, v223
    s_waitcnt lgkmcnt(4)
    v_mfma_f32_32x32x16_bf16 v[224:239], a[160:163], v[184:187], v[224:239]
    s_lshl_b32 s5, s32, 1
    s_add_u32 s5, s4, s5
    s_add_u32 s60, s5, s33
    s_xor_b32 s61, s60, 1
    v_mfma_f32_32x32x16_bf16 a[128:143], v[184:187], a[164:167], a[128:143]
    s_waitcnt lgkmcnt(0)
    v_mfma_f32_32x32x16_bf16 v[224:239], a[168:171], v[188:191], v[224:239]
    s_lshl_b32 s62, s31, 1
    s_add_u32 s62, s62, s34
    s_add_u32 s11, s4, s30
    s_lshl_b32 s4, s60, 15
    s_lshl_b32 s5, s62, 6
    v_mfma_f32_32x32x16_bf16 a[128:143], v[188:191], a[172:175], a[128:143]
    s_add_u32 s63, s4, s5
    v_and_b32 v4, 31, v1
    v_lshlrev_b32 v4, 2, v4
    v_lshl_add_u32 v4, v6, 13, v4
    ds_read_b128 v[192:195], v25 offset:0
    v_lshrrev_b32 v16, 3, v1
    ds_read_b128 v[196:199], v25 offset:32
    ds_read_b128 v[200:203], v25 offset:64
    v_lshrrev_b32 v17, 4, v1
    ds_read_b128 v[204:207], v25 offset:96
    v_cvt_pk_bf16_f32 v32, v224, v225
    v_xor_b32 v17, v17, v16
    v_cvt_pk_bf16_f32 v33, v226, v227
    v_cvt_pk_bf16_f32 v34, v228, v229
    v_cvt_pk_bf16_f32 v35, v230, v231
    v_and_b32 v17, 1, v17
    v_cvt_pk_bf16_f32 v36, v232, v233
    v_cvt_pk_bf16_f32 v37, v234, v235
    v_and_b32 v26, 7, v1
    v_cvt_pk_bf16_f32 v38, v236, v237
    v_cvt_pk_bf16_f32 v39, v238, v239
    v_lshlrev_b32 v26, 4, v26
    v_mfma_f32_32x32x16_bf16 v[48:63], v[240:243], v[32:35], 0
    v_mfma_f32_32x32x16_bf16 v[48:63], v[244:247], v[36:39], v[48:63]
    v_accvgpr_read_b32 v208, a128
    v_lshlrev_b32 v17, 6, v17
    v_accvgpr_read_b32 v209, a129
    v_accvgpr_read_b32 v210, a130
    v_xor_b32 v26, v26, v17
    v_accvgpr_read_b32 v211, a131
    v_accvgpr_read_b32 v212, a132
    v_accvgpr_read_b32 v213, a133
    v_mul_u32_u24 v16, 1024, v16
    v_accvgpr_read_b32 v214, a134
    v_accvgpr_read_b32 v215, a135
    v_add_u32 v26, v26, v16
    v_accvgpr_read_b32 v216, a136
    v_accvgpr_read_b32 v217, a137
    s_lshl_b32 s92, s30, 17
    v_accvgpr_read_b32 v218, a138
    v_accvgpr_read_b32 v219, a139
    v_accvgpr_read_b32 v220, a140
    s_lshl_b32 s3, s31, 7
    v_accvgpr_read_b32 v221, a141
    v_accvgpr_read_b32 v222, a142
    s_add_u32 s92, s92, s3
    v_accvgpr_read_b32 v223, a143
    s_waitcnt lgkmcnt(0)
    v_mul_f32 v208, v208, v192
    s_lshl_b32 s35, s30, 13
    v_mul_f32 v209, v209, v193
    v_mul_f32 v210, v210, v194
    s_add_u32 s35, s35, 32768
    v_mul_f32 v211, v211, v195
    v_mul_f32 v212, v212, v196
    s_add_u32 s3, s92, 0
    v_mul_f32 v213, v213, v197
    v_mul_f32 v214, v214, v198
    v_mul_f32 v215, v215, v199
    s_add_u32 m0, s35, 0
    v_mul_f32 v216, v216, v200
    v_mul_f32 v217, v217, v201
    buffer_load_dwordx4 v26, s[36:39], s3 offen lds
    v_mul_f32 v218, v218, v202
    v_mul_f32 v219, v219, v203
    v_mul_f32 v220, v220, v204
    s_add_u32 s3, s92, 8192
    v_mul_f32 v221, v221, v205
    v_mul_f32 v222, v222, v206
    s_add_u32 m0, s35, 1024
    v_mul_f32 v223, v223, v207
    v_cvt_pk_bf16_f32 v40, v208, v209
    buffer_load_dwordx4 v26, s[36:39], s3 offen lds
    v_cvt_pk_bf16_f32 v41, v210, v211
    v_cvt_pk_bf16_f32 v42, v212, v213
    v_cvt_pk_bf16_f32 v43, v214, v215
    s_add_u32 s3, s92, 16384
    v_cvt_pk_bf16_f32 v44, v216, v217
    v_cvt_pk_bf16_f32 v45, v218, v219
    s_add_u32 m0, s35, 2048
    v_cvt_pk_bf16_f32 v46, v220, v221
    v_cvt_pk_bf16_f32 v47, v222, v223
    ds_write_b128 v20, v[40:43]
    buffer_load_dwordx4 v26, s[36:39], s3 offen lds
    ds_write_b128 v20, v[44:47] offset:1024
    v_max3_f32 v8, v48, v49, v50
    s_add_u32 s3, s92, 24576
    v_min3_f32 v9, v48, v49, v50
    v_max3_f32 v10, v56, v57, v58
    s_add_u32 m0, s35, 3072
    v_min3_f32 v11, v56, v57, v58
    v_max3_f32 v8, v8, v51, v52
    v_min3_f32 v9, v9, v51, v52
    buffer_load_dwordx4 v26, s[36:39], s3 offen lds
    v_max3_f32 v10, v10, v59, v60
    v_min3_f32 v11, v11, v59, v60
    s_add_u32 s3, s92, 32768
    v_max3_f32 v8, v8, v53, v54
    v_min3_f32 v9, v9, v53, v54
    v_max3_f32 v10, v10, v61, v62
    s_add_u32 m0, s35, 4096
    v_min3_f32 v11, v11, v61, v62
    v_max3_f32 v8, v8, v55, v63
    buffer_load_dwordx4 v26, s[36:39], s3 offen lds
    v_min3_f32 v9, v9, v55, v63
    v_max_f32 v8, v8, v10
    s_add_u32 s3, s92, 40960
    v_min_f32 v9, v9, v11
    v_mul_f32 v8, v24, v8
    v_mul_f32 v9, v24, v9
    s_add_u32 m0, s35, 5120
    v_fma_f32 v208, v48, v24, -v8
    v_fma_f32 v209, v49, v24, -v8
    buffer_load_dwordx4 v26, s[36:39], s3 offen lds
    v_fma_f32 v210, v50, v24, -v8
    v_fma_f32 v211, v51, v24, -v8
    s_add_u32 s3, s92, 49152
    v_fma_f32 v212, v52, v24, -v8
    v_fma_f32 v213, v53, v24, -v8
    v_fma_f32 v214, v54, v24, -v8
    s_add_u32 m0, s35, 6144
    v_fma_f32 v215, v55, v24, -v8
    v_fma_f32 v216, v56, v24, -v8
    buffer_load_dwordx4 v26, s[36:39], s3 offen lds
    v_fma_f32 v217, v57, v24, -v8
    v_fma_f32 v218, v58, v24, -v8
    v_fma_f32 v219, v59, v24, -v8
    s_add_u32 s3, s92, 57344
    v_fma_f32 v220, v60, v24, -v8
    v_fma_f32 v221, v61, v24, -v8
    s_add_u32 m0, s35, 7168
    v_fma_f32 v222, v62, v24, -v8
    v_fma_f32 v223, v63, v24, -v8
    buffer_load_dwordx4 v26, s[36:39], s3 offen lds
    v_exp_f32 v208, v208
    v_fma_f32 v48, -v48, v24, v9
    v_exp_f32 v209, v209
    s_lshl_b32 s3, s60, 15
    v_fma_f32 v49, -v49, v24, v9
    v_exp_f32 v210, v210
    s_lshl_b32 s56, s62, 11
    v_fma_f32 v50, -v50, v24, v9
    v_exp_f32 v211, v211
    v_fma_f32 v51, -v51, v24, v9
    s_add_u32 s3, s3, s56
    v_exp_f32 v212, v212
    v_fma_f32 v52, -v52, v24, v9
    s_add_u32 s3, s3, 8388608
    v_exp_f32 v213, v213
    v_fma_f32 v53, -v53, v24, v9
    buffer_store_dwordx4 v[248:251], v3, s[24:27], s3 offen offset:0 sc1
    v_exp_f32 v214, v214
    v_fma_f32 v54, -v54, v24, v9
    v_exp_f32 v215, v215
    buffer_store_dwordx4 v[248:251], v3, s[24:27], s3 offen offset:1024 sc1
    v_fma_f32 v55, -v55, v24, v9
    v_exp_f32 v216, v216
    s_lshl_b32 s3, s62, 14
    v_fma_f32 v56, -v56, v24, v9
    v_exp_f32 v217, v217
    v_fma_f32 v57, -v57, v24, v9
    s_lshl_b32 s56, s60, 7
    v_exp_f32 v218, v218
    v_fma_f32 v58, -v58, v24, v9
    s_add_u32 s3, s3, s56
    v_exp_f32 v219, v219
    v_fma_f32 v59, -v59, v24, v9
    s_add_u32 s3, s3, 12582912
    v_exp_f32 v220, v220
    v_fma_f32 v60, -v60, v24, v9
    v_exp_f32 v221, v221
    buffer_store_dword v248, v4, s[24:27], s3 offen sc1
    v_fma_f32 v61, -v61, v24, v9
    v_exp_f32 v222, v222
    v_and_b32 v27, 31, v1
    v_fma_f32 v62, -v62, v24, v9
    v_exp_f32 v223, v223
    v_fma_f32 v63, -v63, v24, v9
    v_lshlrev_b32 v27, 10, v27
    v_exp_f32 v48, v48
    v_exp_f32 v49, v49
    v_lshl_add_u32 v27, v6, 4, v27
    v_add_f32 v8, v208, v209
    v_exp_f32 v50, v50
    buffer_load_dwordx4 a[0:3], v27, s[12:15], s63 offen offset:0
    v_exp_f32 v51, v51
    v_add_f32 v10, v210, v211
    v_exp_f32 v52, v52
    buffer_load_dwordx4 a[4:7], v27, s[12:15], s63 offen offset:32
    v_add_f32 v8, v8, v212
    v_exp_f32 v53, v53
    s_lshl_b32 s5, s29, 4
    v_add_f32 v10, v10, v213
    v_exp_f32 v54, v54
    v_add_f32 v8, v8, v214
    s_add_u32 s5, s5, s28
    v_exp_f32 v55, v55
    v_add_f32 v10, v10, v215
    s_lshl_b32 s5, s5, 12
    v_exp_f32 v56, v56
    v_add_f32 v8, v8, v216
    s_lshl_b32 s4, s30, 11
    v_exp_f32 v57, v57
    v_add_f32 v10, v10, v217
    v_exp_f32 v58, v58
    s_add_u32 s5, s5, s4
    v_add_f32 v8, v8, v218
    v_exp_f32 v59, v59
    s_add_u32 s5, s5, 131072
    v_add_f32 v10, v10, v219
    v_exp_f32 v60, v60
    v_add_f32 v8, v8, v220
    v_exp_f32 v61, v61
    v_add_f32 v10, v10, v221
    v_exp_f32 v62, v62
    v_add_f32 v8, v8, v222
    v_exp_f32 v63, v63
    v_add_f32 v10, v10, v223
    v_add_f32 v8, v8, v10
    v_add_f32 v9, v48, v49
    v_rcp_f32 v8, v8
    v_add_f32 v11, v50, v51
    v_add_f32 v9, v9, v52
    v_add_f32 v11, v11, v53
    v_add_f32 v9, v9, v54
    v_add_f32 v11, v11, v55
    v_add_f32 v9, v9, v56
    v_add_f32 v11, v11, v57
    v_add_f32 v9, v9, v58
    v_add_f32 v11, v11, v59
    v_add_f32 v9, v9, v60
    v_add_f32 v11, v11, v61
    v_add_f32 v9, v9, v62
    v_add_f32 v11, v11, v63
    v_add_f32 v9, v9, v11
    v_rcp_f32 v9, v9
    v_mul_f32 v208, v208, v8
    v_mul_f32 v209, v209, v8
    v_mul_f32 v210, v210, v8
    v_mul_f32 v211, v211, v8
    v_mul_f32 v212, v212, v8
    v_mul_f32 v213, v213, v8
    v_mul_f32 v214, v214, v8
    v_mul_f32 v215, v215, v8
    v_mul_f32 v216, v216, v8
    v_mul_f32 v217, v217, v8
    v_mul_f32 v218, v218, v8
    v_mul_f32 v219, v219, v8
    v_mul_f32 v220, v220, v8
    v_mul_f32 v221, v221, v8
    v_mul_f32 v222, v222, v8
    v_mul_f32 v223, v223, v8
    v_cvt_pk_bf16_f32 v192, v208, v209
    v_cvt_pk_bf16_f32 v193, v210, v211
    v_cvt_pk_bf16_f32 v194, v212, v213
    v_cvt_pk_bf16_f32 v195, v214, v215
    v_cvt_pk_bf16_f32 v196, v216, v217
    v_cvt_pk_bf16_f32 v197, v218, v219
    v_cvt_pk_bf16_f32 v198, v220, v221
    v_cvt_pk_bf16_f32 v199, v222, v223
    v_mul_f32 v48, v48, v9
    v_mul_f32 v49, v49, v9
    v_mul_f32 v50, v50, v9
    v_mul_f32 v51, v51, v9
    v_mul_f32 v52, v52, v9
    v_mul_f32 v53, v53, v9
    v_mul_f32 v54, v54, v9
    v_mul_f32 v55, v55, v9
    v_mul_f32 v56, v56, v9
    v_mul_f32 v57, v57, v9
    v_mul_f32 v58, v58, v9
    v_mul_f32 v59, v59, v9
    v_mul_f32 v60, v60, v9
    v_mul_f32 v61, v61, v9
    v_mul_f32 v62, v62, v9
    v_mul_f32 v63, v63, v9
    v_cvt_pk_bf16_f32 v200, v48, v49
    v_cvt_pk_bf16_f32 v201, v50, v51
    v_cvt_pk_bf16_f32 v202, v52, v53
    v_cvt_pk_bf16_f32 v203, v54, v55
    v_cvt_pk_bf16_f32 v204, v56, v57
    v_cvt_pk_bf16_f32 v205, v58, v59
    v_cvt_pk_bf16_f32 v206, v60, v61
    v_cvt_pk_bf16_f32 v207, v62, v63
    ds_write_b128 v21, v[192:195] offset:0
    ds_write_b128 v21, v[196:199] offset:16
    ds_write_b128 v21, v[200:203] offset:32
    ds_write_b128 v21, v[204:207] offset:48
    s_waitcnt vmcnt(13)
    s_waitcnt lgkmcnt(0)
    s_barrier
    v_mov_b32 v2, s65
    s_lshl_b32 s3, s28, 4
    s_add_u32 s3, s3, s29
    s_lshl_b32 s3, s3, 6
    s_add_u32 s3, s3, 1310720
    s_cmp_lg_u32 s30, 3
    s_cselect_b32 s3, 0x7f000000, s3
    s_mov_b64 exec, 1
    buffer_store_dword v2, off, s[24:27], s3 sc1
    s_mov_b64 exec, -1
    s_cmp_ge_u32 s30, 2
    s_cbranch_scc1 SKIPKV_8
    ds_read_b128 v[192:195], v22 offset:0
    ds_read_b64_tr_b16 a[144:145], v23 offset:0
    ds_read_b64_tr_b16 a[146:147], v23 offset:640
    ds_read_b128 v[196:199], v22 offset:1024
    ds_read_b64_tr_b16 a[148:149], v23 offset:1280
    ds_read_b64_tr_b16 a[150:151], v23 offset:1920
    ds_read_b128 v[200:203], v22 offset:2048
    ds_read_b64_tr_b16 a[152:153], v23 offset:5120
    ds_read_b64_tr_b16 a[154:155], v23 offset:5760
    ds_read_b128 v[204:207], v22 offset:3072
    ds_read_b64_tr_b16 a[156:157], v23 offset:6400
    ds_read_b64_tr_b16 a[158:159], v23 offset:7040
    ds_read_b128 v[208:211], v22 offset:4096
    ds_read_b64_tr_b16 a[160:161], v23 offset:10240
    ds_read_b64_tr_b16 a[162:163], v23 offset:10880
    ds_read_b128 v[212:215], v22 offset:5120
    ds_read_b64_tr_b16 a[164:165], v23 offset:11520
    ds_read_b64_tr_b16 a[166:167], v23 offset:12160
    ds_read_b128 v[216:219], v22 offset:6144
    ds_read_b64_tr_b16 a[168:169], v23 offset:15360
    ds_read_b64_tr_b16 a[170:171], v23 offset:16000
    ds_read_b128 v[220:223], v22 offset:7168
    ds_read_b64_tr_b16 a[172:173], v23 offset:16640
    ds_read_b64_tr_b16 a[174:175], v23 offset:17280
    v_and_b32 v15, 16, v1
    v_cmp_eq_u32 vcc, 0, v15
    v_mov_b32 v35, s65
    v_mov_b32 v38, s65
    v_mov_b32 v39, s65
    s_waitcnt lgkmcnt(15)
    v_cndmask_b32 v192, v7, v192, vcc
    v_cndmask_b32 v193, v7, v193, vcc
    v_cndmask_b32 v194, v7, v194, vcc
    v_cndmask_b32 v195, v7, v195, vcc
    s_nop 1
    v_mfma_f32_32x32x16_bf16 v[48:63], v[192:195], a[144:147], 0
    v_cndmask_b32 v196, v7, v196, vcc
    v_cndmask_b32 v197, v7, v197, vcc
    v_cndmask_b32 v198, v7, v198, vcc
    v_cndmask_b32 v199, v7, v199, vcc
    s_nop 1
    v_mfma_f32_32x32x16_bf16 v[48:63], v[196:199], a[148:151], v[48:63]
    v_cndmask_b32 v200, v7, v200, vcc
    v_cndmask_b32 v201, v7, v201, vcc
    v_cndmask_b32 v202, v7, v202, vcc
    v_cndmask_b32 v203, v7, v203, vcc
    s_nop 1
    v_mfma_f32_32x32x16_bf16 v[48:63], v[200:203], a[152:155], v[48:63]
    s_waitcnt lgkmcnt(12)
    v_cndmask_b32 v204, v7, v204, vcc
    v_cndmask_b32 v205, v7, v205, vcc
    v_cndmask_b32 v206, v7, v206, vcc
    v_cndmask_b32 v207, v7, v207, vcc
    s_nop 1
    v_mfma_f32_32x32x16_bf16 v[48:63], v[204:207], a[156:159], v[48:63]
    s_waitcnt lgkmcnt(9)
    v_cndmask_b32 v208, v7, v208, vcc
    v_cndmask_b32 v209, v7, v209, vcc
    v_cndmask_b32 v210, v7, v210, vcc
    v_cndmask_b32 v211, v7, v211, vcc
    s_nop 1
    v_mfma_f32_32x32x16_bf16 v[48:63], v[208:211], a[160:163], v[48:63]
    s_waitcnt lgkmcnt(6)
    v_cndmask_b32 v212, v7, v212, vcc
    v_cndmask_b32 v213, v7, v213, vcc
    v_cndmask_b32 v214, v7, v214, vcc
    v_cndmask_b32 v215, v7, v215, vcc
    s_nop 1
    v_mfma_f32_32x32x16_bf16 v[48:63], v[212:215], a[164:167], v[48:63]
    s_waitcnt lgkmcnt(3)
    v_cndmask_b32 v216, v7, v216, vcc
    v_cndmask_b32 v217, v7, v217, vcc
    v_cndmask_b32 v218, v7, v218, vcc
    v_cndmask_b32 v219, v7, v219, vcc
    s_nop 1
    v_mfma_f32_32x32x16_bf16 v[48:63], v[216:219], a[168:171], v[48:63]
    s_waitcnt lgkmcnt(0)
    v_cndmask_b32 v220, v7, v220, vcc
    v_cndmask_b32 v221, v7, v221, vcc
    v_cndmask_b32 v222, v7, v222, vcc
    v_cndmask_b32 v223, v7, v223, vcc
    s_nop 1
    v_mfma_f32_32x32x16_bf16 v[48:63], v[220:223], a[172:175], v[48:63]
    s_nop 11
    v_cvt_pk_bf16_f32 v32, v48, v49
    v_cvt_pk_bf16_f32 v33, v50, v51
    v_cvt_pk_bf16_f32 v34, v52, v53
    buffer_store_dwordx4 v[32:35], v3, s[24:27], s5 offen sc1
    v_cvt_pk_bf16_f32 v36, v54, v55
    v_mov_b32 v37, v56
    buffer_store_dwordx4 v[36:39], v3, s[24:27], s5 offen offset:1024 sc1
    s_nop 3
SKIPKV_8:
    ds_read_b64_tr_b16 a[240:241], v18 offset:0
    s_lshr_b32 s5, s28, 1
    ds_read_b64_tr_b16 a[242:243], v18 offset:256
    s_cmp_lt_u32 s30, 2
    ds_read_b64_tr_b16 a[244:245], v18 offset:1024
    s_cselect_b32 s4, s31, s5
    ds_read_b64_tr_b16 a[246:247], v18 offset:1280
    s_cselect_b32 s5, 0, 16384
    ds_read_b64_tr_b16 a[248:249], v18 offset:2048
    s_lshl_b32 s4, s4, 11
    ds_read_b64_tr_b16 a[250:251], v18 offset:2304
    s_cmp_eq_u32 s33, 1
    ds_read_b64_tr_b16 a[252:253], v18 offset:3072
    s_cselect_b32 s5, 32768, s5
    ds_read_b64_tr_b16 a[254:255], v18 offset:3328
    s_cselect_b64 s[6:7], -1, 0
    s_waitcnt lgkmcnt(6)
    s_add_u32 s4, s4, s5
    v_mfma_f32_32x32x16_bf16 v[224:239], a[240:243], v[64:67], 0
    s_add_u32 s4, s4, 32768
    ds_read_b64_tr_b16 a[240:241], v18 offset:4096
    v_lshlrev_b32 v25, 5, v1
    ds_read_b64_tr_b16 a[242:243], v18 offset:4352
    s_waitcnt lgkmcnt(6)
    buffer_load_dwordx4 v[40:43], v25, s[24:27], s4 offen sc1
    v_mfma_f32_32x32x16_bf16 v[224:239], a[244:247], v[68:71], v[224:239]
    buffer_load_dwordx4 v[44:47], v25, s[24:27], s4 offen offset:16 sc1
    ds_read_b64_tr_b16 a[244:245], v18 offset:5120
    s_waitcnt vmcnt(8)
    ds_read_b64_tr_b16 a[246:247], v18 offset:5376
    s_mov_b32 s5, 5462
    s_waitcnt lgkmcnt(6)
    v_add_u32 v13, 0, v1
    v_mfma_f32_32x32x16_bf16 v[224:239], a[248:251], v[72:75], v[224:239]
    v_mul_u32_u24 v14, s5, v13
    ds_read_b64_tr_b16 a[248:249], v18 offset:6144
    v_lshrrev_b32 v14, 16, v14
    ds_read_b64_tr_b16 a[250:251], v18 offset:6400
    v_mul_u32_u24 v15, 12, v14
    s_waitcnt lgkmcnt(6)
    v_sub_u32 v15, v13, v15
    v_mfma_f32_32x32x16_bf16 v[224:239], a[252:255], v[76:79], v[224:239]
    v_mul_u32_u24 v14, 2752, v14
    ds_read_b64_tr_b16 a[252:253], v18 offset:7168
    v_lshl_add_u32 v252, v15, 4, v14
    ds_read_b64_tr_b16 a[254:255], v18 offset:7424
    s_waitcnt lgkmcnt(6)
    v_add_u32 v13, 64, v1
    v_mfma_f32_32x32x16_bf16 v[224:239], a[240:243], v[80:83], v[224:239]
    v_mul_u32_u24 v14, s5, v13
    ds_read_b64_tr_b16 a[240:241], v18 offset:8192
    v_lshrrev_b32 v14, 16, v14
    ds_read_b64_tr_b16 a[242:243], v18 offset:8448
    v_mul_u32_u24 v15, 12, v14
    s_waitcnt lgkmcnt(6)
    v_sub_u32 v15, v13, v15
    v_mfma_f32_32x32x16_bf16 v[224:239], a[244:247], v[84:87], v[224:239]
    v_mul_u32_u24 v14, 2752, v14
    ds_read_b64_tr_b16 a[244:245], v18 offset:9216
    v_lshl_add_u32 v253, v15, 4, v14
    ds_read_b64_tr_b16 a[246:247], v18 offset:9472
    v_add_u32 v13, 128, v1
    s_waitcnt lgkmcnt(6)
    v_mul_u32_u24 v14, s5, v13
    v_mfma_f32_32x32x16_bf16 v[224:239], a[248:251], v[88:91], v[224:239]
    v_lshrrev_b32 v14, 16, v14
    ds_read_b64_tr_b16 a[248:249], v18 offset:10240
    ds_read_b64_tr_b16 a[250:251], v18 offset:10496
    v_mul_u32_u24 v15, 12, v14
    s_waitcnt lgkmcnt(6)
    v_sub_u32 v15, v13, v15
    v_mfma_f32_32x32x16_bf16 v[224:239], a[252:255], v[92:95], v[224:239]
    v_mul_u32_u24 v14, 2752, v14
    ds_read_b64_tr_b16 a[252:253], v18 offset:11264
    v_lshl_add_u32 v254, v15, 4, v14
    ds_read_b64_tr_b16 a[254:255], v18 offset:11520
    s_mul_i32 s58, s30, 44032
    s_waitcnt lgkmcnt(6)
    s_lshl_b32 s5, s10, 5
    v_mfma_f32_32x32x16_bf16 v[224:239], a[240:243], v[96:99], v[224:239]
    s_add_u32 s58, s58, s5
    ds_read_b64_tr_b16 a[240:241], v18 offset:12288
    s_mul_i32 s59, s30, 6400
    ds_read_b64_tr_b16 a[242:243], v18 offset:12544
    s_lshr_b32 s3, s28, 1
    s_waitcnt lgkmcnt(6)
    s_add_u32 s3, s3, 0
    v_mfma_f32_32x32x16_bf16 v[224:239], a[244:247], v[100:103], v[224:239]
    s_and_b32 s3, s3, 7
    ds_read_b64_tr_b16 a[244:245], v18 offset:13312
    ds_read_b64_tr_b16 a[246:247], v18 offset:13568
    s_mul_i32 s3, s3, 176128
    s_waitcnt lgkmcnt(6)
    s_add_u32 s3, s3, s58
    v_mfma_f32_32x32x16_bf16 v[224:239], a[248:251], v[104:107], v[224:239]
    s_add_u32 m0, s59, 76800
    ds_read_b64_tr_b16 a[248:249], v18 offset:14336
    buffer_load_dwordx4 v252, s[40:43], s3 offen lds
    ds_read_b64_tr_b16 a[250:251], v18 offset:14592
    s_add_u32 m0, s59, 77824
    s_waitcnt lgkmcnt(6)
    buffer_load_dwordx4 v253, s[40:43], s3 offen lds
    v_mfma_f32_32x32x16_bf16 v[224:239], a[252:255], v[108:111], v[224:239]
    s_add_u32 m0, s59, 78848
    ds_read_b64_tr_b16 a[252:253], v18 offset:15360
    buffer_load_dwordx4 v254, s[40:43], s3 offen lds
    ds_read_b64_tr_b16 a[254:255], v18 offset:15616
    s_add_u32 m0, s59, 79904
    s_waitcnt lgkmcnt(6)
    buffer_load_dwordx4 v252, s[44:47], s3 offen lds
    v_mfma_f32_32x32x16_bf16 v[224:239], a[240:243], v[112:115], v[224:239]
    s_add_u32 m0, s59, 80928
    ds_read_b64_tr_b16 a[240:241], v18 offset:16384
    ds_read_b64_tr_b16 a[242:243], v18 offset:16640
    buffer_load_dwordx4 v253, s[44:47], s3 offen lds
    s_waitcnt lgkmcnt(6)
    s_add_u32 m0, s59, 81952
    v_mfma_f32_32x32x16_bf16 v[224:239], a[244:247], v[116:119], v[224:239]
    buffer_load_dwordx4 v254, s[44:47], s3 offen lds
    ds_read_b64_tr_b16 a[244:245], v18 offset:17408
    v_bfe_u32 v13, v1, 4, 1
    ds_read_b64_tr_b16 a[246:247], v18 offset:17664
    v_and_b32 v16, 1, v1
    s_waitcnt lgkmcnt(6)
    v_lshlrev_b32 v16, 4, v16
    v_mfma_f32_32x32x16_bf16 v[224:239], a[248:251], v[120:123], v[224:239]
    v_lshl_add_u32 v16, v13, 5, v16
    ds_read_b64_tr_b16 a[248:249], v18 offset:18432
    v_bfe_u32 v13, v1, 1, 1
    ds_read_b64_tr_b16 a[250:251], v18 offset:18688
    v_lshl_add_u32 v16, v13, 3, v16
    s_waitcnt lgkmcnt(6)
    v_bfe_u32 v13, v1, 4, 1
    v_mfma_f32_32x32x16_bf16 v[224:239], a[252:255], v[124:127], v[224:239]
    ds_read_b64_tr_b16 a[252:253], v18 offset:19456
    v_bfe_u32 v13, v1, 2, 2
    ds_read_b64_tr_b16 a[254:255], v18 offset:19712
    v_lshrrev_b32 v17, 1, v13
    s_waitcnt lgkmcnt(6)
    v_xor_b32 v17, v17, v13
    v_mfma_f32_32x32x16_bf16 v[224:239], a[240:243], v[128:131], v[224:239]
    v_xor_b32 v17, s34, v17
    ds_read_b64_tr_b16 a[240:241], v18 offset:20480
    v_and_b32 v17, 1, v17
    ds_read_b64_tr_b16 a[242:243], v18 offset:20736
    v_lshl_add_u32 v16, v17, 6, v16
    s_waitcnt lgkmcnt(6)
    v_lshl_add_u32 v16, v13, 7, v16
    v_mfma_f32_32x32x16_bf16 v[224:239], a[244:247], v[132:135], v[224:239]
    v_lshrrev_b32 v13, 5, v1
    ds_read_b64_tr_b16 a[244:245], v18 offset:21504
    v_lshl_add_u32 v16, v13, 10, v16
    ds_read_b64_tr_b16 a[246:247], v18 offset:21760
    v_add_u32 v16, s35, v16
    s_waitcnt lgkmcnt(6)
    v_xor_b32 v17, 64, v16
    v_mfma_f32_32x32x16_bf16 v[224:239], a[248:251], v[136:139], v[224:239]
    ds_read_b64_tr_b16 a[248:249], v18 offset:22528
    ds_read_b64_tr_b16 a[250:251], v18 offset:22784
    ds_read_b64_tr_b16 a[176:177], v16 offset:0
    s_waitcnt lgkmcnt(7)
    ds_read_b64_tr_b16 a[178:179], v16 offset:512
    v_mfma_f32_32x32x16_bf16 v[224:239], a[252:255], v[140:143], v[224:239]
    ds_read_b64_tr_b16 a[180:181], v17 offset:0
    ds_read_b64_tr_b16 a[252:253], v18 offset:23552
    ds_read_b64_tr_b16 a[182:183], v17 offset:512
    ds_read_b64_tr_b16 a[254:255], v18 offset:23808
    ds_read_b64_tr_b16 a[184:185], v16 offset:2048
    s_waitcnt lgkmcnt(11)
    ds_read_b64_tr_b16 a[186:187], v16 offset:2560
    v_mfma_f32_32x32x16_bf16 v[224:239], a[240:243], v[144:147], v[224:239]
    ds_read_b64_tr_b16 a[188:189], v17 offset:2048
    ds_read_b64_tr_b16 a[240:241], v18 offset:24576
    ds_read_b64_tr_b16 a[190:191], v17 offset:2560
    ds_read_b64_tr_b16 a[242:243], v18 offset:24832
    ds_read_b64_tr_b16 a[192:193], v16 offset:4096
    s_waitcnt lgkmcnt(15)
    ds_read_b64_tr_b16 a[194:195], v16 offset:4608
    v_mfma_f32_32x32x16_bf16 v[224:239], a[244:247], v[148:151], v[224:239]
    ds_read_b64_tr_b16 a[244:245], v18 offset:25600
    ds_read_b64_tr_b16 a[196:197], v17 offset:4096
    ds_read_b64_tr_b16 a[246:247], v18 offset:25856
    ds_read_b64_tr_b16 a[198:199], v17 offset:4608
    s_waitcnt lgkmcnt(15)
    ds_read_b64_tr_b16 a[200:201], v16 offset:6144
    v_mfma_f32_32x32x16_bf16 v[224:239], a[248:251], v[152:155], v[224:239]
    ds_read_b64_tr_b16 a[202:203], v16 offset:6656
    ds_read_b64_tr_b16 a[248:249], v18 offset:26624
    ds_read_b64_tr_b16 a[204:205], v17 offset:6144
    ds_read_b64_tr_b16 a[250:251], v18 offset:26880
    ds_read_b64_tr_b16 a[206:207], v17 offset:6656
    s_waitcnt lgkmcnt(15)
    s_waitcnt lgkmcnt(0)
    v_mfma_f32_32x32x16_bf16 v[224:239], a[252:255], v[156:159], v[224:239]
    s_add_u32 s3, s92, 65536
    ds_read_b64_tr_b16 a[252:253], v18 offset:27648
    s_add_u32 m0, s35, 0
    ds_read_b64_tr_b16 a[254:255], v18 offset:27904
    buffer_load_dwordx4 v26, s[36:39], s3 offen lds
    v_mfma_f32_32x32x16_bf16 v[224:239], a[240:243], v[160:163], v[224:239]
    s_add_u32 s3, s92, 73728
    ds_read_b64_tr_b16 a[240:241], v18 offset:28672
    s_add_u32 m0, s35, 1024
    ds_read_b64_tr_b16 a[242:243], v18 offset:28928
    buffer_load_dwordx4 v26, s[36:39], s3 offen lds
    s_add_u32 s3, s92, 81920
    v_mfma_f32_32x32x16_bf16 v[224:239], a[244:247], v[164:167], v[224:239]
    s_add_u32 m0, s35, 2048
    ds_read_b64_tr_b16 a[244:245], v18 offset:29696
    buffer_load_dwordx4 v26, s[36:39], s3 offen lds
    ds_read_b64_tr_b16 a[246:247], v18 offset:29952
    s_add_u32 s3, s92, 90112
    s_add_u32 m0, s35, 3072
    v_mfma_f32_32x32x16_bf16 v[224:239], a[248:251], v[168:171], v[224:239]
    buffer_load_dwordx4 v26, s[36:39], s3 offen lds
    ds_read_b64_tr_b16 a[248:249], v18 offset:30720
    s_add_u32 s3, s92, 98304
    ds_read_b64_tr_b16 a[250:251], v18 offset:30976
    s_add_u32 m0, s35, 4096
    s_waitcnt lgkmcnt(6)
    v_mfma_f32_32x32x16_bf16 v[224:239], a[252:255], v[172:175], v[224:239]
    buffer_load_dwordx4 v26, s[36:39], s3 offen lds
    ds_read_b64_tr_b16 a[252:253], v18 offset:31744
    s_add_u32 s3, s92, 106496
    ds_read_b64_tr_b16 a[254:255], v18 offset:32000
    s_add_u32 m0, s35, 5120
    s_waitcnt lgkmcnt(6)
    buffer_load_dwordx4 v26, s[36:39], s3 offen lds
    v_mfma_f32_32x32x16_bf16 v[224:239], a[240:243], v[176:179], v[224:239]
    s_add_u32 s3, s92, 114688
    s_waitcnt lgkmcnt(4)
    s_add_u32 m0, s35, 6144
    v_mfma_f32_32x32x16_bf16 v[224:239], a[244:247], v[180:183], v[224:239]
    buffer_load_dwordx4 v26, s[36:39], s3 offen lds
    s_waitcnt lgkmcnt(2)
    s_add_u32 s3, s92, 122880
    v_mfma_f32_32x32x16_bf16 v[224:239], a[248:251], v[184:187], v[224:239]
    s_add_u32 m0, s35, 7168
    s_waitcnt lgkmcnt(0)
    buffer_load_dwordx4 v26, s[36:39], s3 offen lds
    v_mfma_f32_32x32x16_bf16 v[224:239], a[252:255], v[188:191], v[224:239]
    s_nop 11
    v_cvt_pk_bf16_f32 v32, v224, v225
    s_lshl_b32 s56, s29, 16
    v_cvt_pk_bf16_f32 v33, v226, v227
    v_cvt_pk_bf16_f32 v34, v228, v229
    v_cvt_pk_bf16_f32 v35, v230, v231
    v_cvt_pk_bf16_f32 v36, v232, v233
    s_lshl_b32 s5, s34, 15
    v_cvt_pk_bf16_f32 v37, v234, v235
    v_cvt_pk_bf16_f32 v38, v236, v237
    v_cvt_pk_bf16_f32 v39, v238, v239
    v_mfma_f32_32x32x16_bf16 v[48:63], v[240:243], v[32:35], 0
    s_add_u32 s56, s56, s5
    v_mfma_f32_32x32x16_bf16 v[48:63], v[244:247], v[36:39], v[48:63]
    s_nop 11
    v_max3_f32 v8, v48, v49, v50
    v_min3_f32 v9, v48, v49, v50
    v_max3_f32 v10, v56, v57, v58
    v_min3_f32 v11, v56, v57, v58
    s_lshl_b32 s5, s33, 11
    v_max3_f32 v8, v8, v51, v52
    v_min3_f32 v9, v9, v51, v52
    v_max3_f32 v10, v10, v59, v60
    v_min3_f32 v11, v11, v59, v60
    s_add_u32 s56, s56, s5
    v_max3_f32 v8, v8, v53, v54
    v_min3_f32 v9, v9, v53, v54
    v_max3_f32 v10, v10, v61, v62
    v_min3_f32 v11, v11, v61, v62
    s_add_u32 s56, s56, 131072
    v_max3_f32 v8, v8, v55, v63
    v_min3_f32 v9, v9, v55, v63
    v_max_f32 v8, v8, v10
    v_min_f32 v9, v9, v11
    v_mul_f32 v8, v24, v8
    v_bfe_u32 v21, v1, 2, 2
    v_mul_f32 v9, v24, v9
    v_fma_f32 v208, v48, v24, -v8
    v_fma_f32 v209, v49, v24, -v8
    v_fma_f32 v210, v50, v24, -v8
    v_lshl_add_u32 v21, v6, 3, v21
    v_fma_f32 v211, v51, v24, -v8
    v_fma_f32 v212, v52, v24, -v8
    v_fma_f32 v213, v53, v24, -v8
    v_fma_f32 v214, v54, v24, -v8
    v_fma_f32 v215, v55, v24, -v8
    v_lshl_add_u32 v20, v21, 6, v5
    v_fma_f32 v216, v56, v24, -v8
    v_fma_f32 v217, v57, v24, -v8
    v_fma_f32 v218, v58, v24, -v8
    v_fma_f32 v219, v59, v24, -v8
    v_add_u32 v20, 65536, v20
    v_fma_f32 v220, v60, v24, -v8
    v_fma_f32 v221, v61, v24, -v8
    v_fma_f32 v222, v62, v24, -v8
    v_fma_f32 v223, v63, v24, -v8
    v_and_b32 v19, 31, v1
    v_exp_f32 v208, v208
    v_fma_f32 v48, -v48, v24, v9
    v_exp_f32 v209, v209
    v_fma_f32 v49, -v49, v24, v9
    v_exp_f32 v210, v210
    v_lshlrev_b32 v19, 6, v19
    v_fma_f32 v50, -v50, v24, v9
    v_exp_f32 v211, v211
    v_fma_f32 v51, -v51, v24, v9
    v_exp_f32 v212, v212
    s_lshl_b32 s5, s30, 11
    v_fma_f32 v52, -v52, v24, v9
    v_exp_f32 v213, v213
    v_fma_f32 v53, -v53, v24, v9
    v_exp_f32 v214, v214
    v_fma_f32 v54, -v54, v24, v9
    s_add_u32 s5, s5, 65536
    v_exp_f32 v215, v215
    v_fma_f32 v55, -v55, v24, v9
    v_exp_f32 v216, v216
    v_fma_f32 v56, -v56, v24, v9
    v_add_u32 v19, s5, v19
    v_exp_f32 v217, v217
    v_fma_f32 v57, -v57, v24, v9
    v_exp_f32 v218, v218
    v_fma_f32 v58, -v58, v24, v9
    v_lshl_add_u32 v18, v6, 4, v19
    v_exp_f32 v219, v219
    v_fma_f32 v59, -v59, v24, v9
    v_exp_f32 v220, v220
    v_fma_f32 v60, -v60, v24, v9
    v_exp_f32 v221, v221
    v_lshl_add_u32 v19, v6, 3, v19
    v_fma_f32 v61, -v61, v24, v9
    v_exp_f32 v222, v222
    v_fma_f32 v62, -v62, v24, v9
    v_exp_f32 v223, v223
    s_add_u32 s3, s56, 0
    v_fma_f32 v63, -v63, v24, v9
    v_exp_f32 v48, v48
    v_exp_f32 v49, v49
    v_add_f32 v8, v208, v209
    v_exp_f32 v50, v50
    buffer_load_dwordx4 v[64:67], v3, s[24:27], s3 offen offset:0 sc1
    v_exp_f32 v51, v51
    v_add_f32 v10, v210, v211
    v_exp_f32 v52, v52
    v_add_f32 v8, v8, v212
    buffer_load_dwordx4 v[68:71], v3, s[24:27], s3 offen offset:1024 sc1
    v_exp_f32 v53, v53
    v_add_f32 v10, v10, v213
    v_exp_f32 v54, v54
    v_add_f32 v8, v8, v214
    s_add_u32 s3, s56, 4096
    v_exp_f32 v55, v55
    v_add_f32 v10, v10, v215
    v_exp_f32 v56, v56
    v_add_f32 v8, v8, v216
    v_exp_f32 v57, v57
    buffer_load_dwordx4 v[72:75], v3, s[24:27], s3 offen offset:0 sc1
    v_add_f32 v10, v10, v217
    v_exp_f32 v58, v58
    v_add_f32 v8, v8, v218
    v_exp_f32 v59, v59
    buffer_load_dwordx4 v[76:79], v3, s[24:27], s3 offen offset:1024 sc1
    v_add_f32 v10, v10, v219
    v_exp_f32 v60, v60
    v_add_f32 v8, v8, v220
    v_exp_f32 v61, v61
    s_add_u32 s3, s56, 8192
    v_add_f32 v10, v10, v221
    v_exp_f32 v62, v62
    v_add_f32 v8, v8, v222
    v_exp_f32 v63, v63
    v_add_f32 v10, v10, v223
    buffer_load_dwordx4 v[80:83], v3, s[24:27], s3 offen offset:0 sc1
    v_add_f32 v8, v8, v10
    v_add_f32 v9, v48, v49
    v_rcp_f32 v8, v8
    v_add_f32 v11, v50, v51
    buffer_load_dwordx4 v[84:87], v3, s[24:27], s3 offen offset:1024 sc1
    v_add_f32 v9, v9, v52
    v_add_f32 v11, v11, v53
    v_add_f32 v9, v9, v54
    v_add_f32 v11, v11, v55
    v_add_f32 v9, v9, v56
    s_add_u32 s3, s56, 12288
    v_add_f32 v11, v11, v57
    v_add_f32 v9, v9, v58
    v_add_f32 v11, v11, v59
    v_add_f32 v9, v9, v60
    buffer_load_dwordx4 v[88:91], v3, s[24:27], s3 offen offset:0 sc1
    v_add_f32 v11, v11, v61
    v_add_f32 v9, v9, v62
    v_add_f32 v11, v11, v63
    v_add_f32 v9, v9, v11
    buffer_load_dwordx4 v[92:95], v3, s[24:27], s3 offen offset:1024 sc1
    v_rcp_f32 v9, v9
    v_mul_f32 v208, v208, v8
    v_mul_f32 v209, v209, v8
    v_mul_f32 v210, v210, v8
    v_mul_f32 v211, v211, v8
    s_add_u32 s3, s56, 16384
    v_mul_f32 v212, v212, v8
    v_mul_f32 v213, v213, v8
    v_mul_f32 v214, v214, v8
    v_mul_f32 v215, v215, v8
    buffer_load_dwordx4 v[96:99], v3, s[24:27], s3 offen offset:0 sc1
    v_mul_f32 v216, v216, v8
    v_mul_f32 v217, v217, v8
    v_mul_f32 v218, v218, v8
    v_mul_f32 v219, v219, v8
    v_mul_f32 v220, v220, v8
    buffer_load_dwordx4 v[100:103], v3, s[24:27], s3 offen offset:1024 sc1
    v_mul_f32 v221, v221, v8
    v_mul_f32 v222, v222, v8
    v_mul_f32 v223, v223, v8
    v_cvt_pk_bf16_f32 v192, v208, v209
    s_add_u32 s3, s56, 20480
    v_cvt_pk_bf16_f32 v193, v210, v211
    v_cvt_pk_bf16_f32 v194, v212, v213
    v_cvt_pk_bf16_f32 v195, v214, v215
    v_cvt_pk_bf16_f32 v196, v216, v217
    buffer_load_dwordx4 v[104:107], v3, s[24:27], s3 offen offset:0 sc1
    v_cvt_pk_bf16_f32 v197, v218, v219
    v_cvt_pk_bf16_f32 v198, v220, v221
    v_cvt_pk_bf16_f32 v199, v222, v223
    v_mul_f32 v48, v48, v9
    v_mul_f32 v49, v49, v9
    buffer_load_dwordx4 v[108:111], v3, s[24:27], s3 offen offset:1024 sc1
    v_mul_f32 v50, v50, v9
    v_mul_f32 v51, v51, v9
    v_mul_f32 v52, v52, v9
    v_mul_f32 v53, v53, v9
    s_add_u32 s3, s56, 24576
    v_mul_f32 v54, v54, v9
    v_mul_f32 v55, v55, v9
    v_mul_f32 v56, v56, v9
    v_mul_f32 v57, v57, v9
    v_mul_f32 v58, v58, v9
    buffer_load_dwordx4 v[112:115], v3, s[24:27], s3 offen offset:0 sc1
    v_mul_f32 v59, v59, v9
    v_mul_f32 v60, v60, v9
    v_mul_f32 v61, v61, v9
    v_mul_f32 v62, v62, v9
    buffer_load_dwordx4 v[116:119], v3, s[24:27], s3 offen offset:1024 sc1
    v_mul_f32 v63, v63, v9
    v_cvt_pk_bf16_f32 v200, v48, v49
    v_cvt_pk_bf16_f32 v201, v50, v51
    v_cvt_pk_bf16_f32 v202, v52, v53
    s_add_u32 s3, s56, 28672
    v_cvt_pk_bf16_f32 v203, v54, v55
    v_cvt_pk_bf16_f32 v204, v56, v57
    v_cvt_pk_bf16_f32 v205, v58, v59
    v_cvt_pk_bf16_f32 v206, v60, v61
    v_cvt_pk_bf16_f32 v207, v62, v63
    buffer_load_dwordx4 v[120:123], v3, s[24:27], s3 offen offset:0 sc1
    v_permlane32_swap_b32 v192, v196
    v_permlane32_swap_b32 v200, v204
    v_permlane32_swap_b32 v193, v197
    v_permlane32_swap_b32 v201, v205
    buffer_load_dwordx4 v[124:127], v3, s[24:27], s3 offen offset:1024 sc1
    v_permlane32_swap_b32 v194, v198
    v_permlane32_swap_b32 v202, v206
    v_permlane32_swap_b32 v195, v199
    v_permlane32_swap_b32 v203, v207
    s_mov_b32 s57, 0
    v_mov_b32 v12, s65
    s_waitcnt vmcnt(16)
PMC_10:
    v_xor_b32 v14, v41, v12
    v_bitop3_b32 v14, v14, v43, v12 bitop3:0xf6
    v_bitop3_b32 v14, v14, v45, v12 bitop3:0xf6
    v_bitop3_b32 v14, v14, v47, v12 bitop3:0xf6
    v_cmp_ne_u32 vcc, 0, v14
    s_cbranch_vccnz PM_9
PMD_11:
    ds_read_b64_tr_b16 a[208:209], v16 offset:0
    ds_read_b64_tr_b16 a[210:211], v16 offset:512
    ds_read_b64_tr_b16 a[212:213], v17 offset:0
    ds_read_b64_tr_b16 a[214:215], v17 offset:512
    ds_read_b64_tr_b16 a[216:217], v16 offset:2048
    ds_read_b64_tr_b16 a[218:219], v16 offset:2560
    ds_read_b64_tr_b16 a[220:221], v17 offset:2048
    ds_read_b64_tr_b16 a[222:223], v17 offset:2560
    ds_read_b64_tr_b16 a[224:225], v16 offset:4096
    ds_read_b64_tr_b16 a[226:227], v16 offset:4608
    ds_read_b64_tr_b16 a[228:229], v17 offset:4096
    ds_read_b64_tr_b16 a[230:231], v17 offset:4608
    ds_read_b64_tr_b16 a[232:233], v16 offset:6144
    ds_read_b64_tr_b16 a[234:235], v16 offset:6656
    ds_read_b64_tr_b16 a[236:237], v17 offset:6144
    ds_read_b64_tr_b16 a[238:239], v17 offset:6656
    v_add_f32 v40, v40, v42
    v_add_f32 v44, v44, v46
    v_add_f32 v40, v40, v44
    v_cvt_pk_bf16_f32 v41, v40, v40
    v_lshlrev_b32 v40, 16, v41
    v_add_f32 v42, 1.0, v40
    v_cvt_pk_bf16_f32 v41, v42, v42
    v_lshlrev_b32 v42, 16, v41
    v_cndmask_b32 v48, v40, v42, s[6:7]
    v_lshlrev_b32 v13, 2, v0
    v_add_u32 v13, 161792, v13
    ds_write_b32 v13, v48
    v_lshlrev_b32 v14, 1, v0
    v_add_u32 v14, 162816, v14
    ds_write_b16_d16_hi v14, v48
    s_mov_b32 s6, 0x00003f80
    s_mov_b32 s7, 0x3f800000
    s_nop 1
PAC_13:
    v_mov_b32 v32, 0
    v_mov_b32 v33, 0
    v_mov_b32 v34, 0
    v_mov_b32 v35, 0
    v_mov_b32 v36, 0
    v_mov_b32 v37, 0
    v_mov_b32 v38, 0
    v_mov_b32 v39, 0
    v_mov_b32 v40, 0
    v_mov_b32 v13, 0
    s_waitcnt vmcnt(14)
    v_dot2c_f32_bf16 v32, s6, v64
    v_dot2c_f32_bf16 v33, s7, v64
    v_dot2c_f32_bf16 v34, s6, v65
    v_dot2c_f32_bf16 v35, s7, v65
    v_dot2c_f32_bf16 v36, s6, v66
    v_dot2c_f32_bf16 v37, s7, v66
    v_dot2c_f32_bf16 v38, s6, v68
    v_dot2c_f32_bf16 v39, s7, v68
    v_add_f32 v40, v40, v69
    v_bitop3_b32 v13, v13, v67, v12 bitop3:0xf6
    v_bitop3_b32 v13, v13, v71, v12 bitop3:0xf6
    s_waitcnt vmcnt(12)
    v_dot2c_f32_bf16 v32, s6, v72
    v_dot2c_f32_bf16 v33, s7, v72
    v_dot2c_f32_bf16 v34, s6, v73
    v_dot2c_f32_bf16 v35, s7, v73
    v_dot2c_f32_bf16 v36, s6, v74
    v_dot2c_f32_bf16 v37, s7, v74
    v_dot2c_f32_bf16 v38, s6, v76
    v_dot2c_f32_bf16 v39, s7, v76
    v_add_f32 v40, v40, v77
    v_bitop3_b32 v13, v13, v75, v12 bitop3:0xf6
    v_bitop3_b32 v13, v13, v79, v12 bitop3:0xf6
    s_waitcnt vmcnt(10)
    v_dot2c_f32_bf16 v32, s6, v80
    v_dot2c_f32_bf16 v33, s7, v80
    v_dot2c_f32_bf16 v34, s6, v81
    v_dot2c_f32_bf16 v35, s7, v81
    v_dot2c_f32_bf16 v36, s6, v82
    v_dot2c_f32_bf16 v37, s7, v82
    v_dot2c_f32_bf16 v38, s6, v84
    v_dot2c_f32_bf16 v39, s7, v84
    v_add_f32 v40, v40, v85
    v_bitop3_b32 v13, v13, v83, v12 bitop3:0xf6
    v_bitop3_b32 v13, v13, v87, v12 bitop3:0xf6
    s_waitcnt vmcnt(8)
    v_dot2c_f32_bf16 v32, s6, v88
    v_dot2c_f32_bf16 v33, s7, v88
    v_dot2c_f32_bf16 v34, s6, v89
    v_dot2c_f32_bf16 v35, s7, v89
    v_dot2c_f32_bf16 v36, s6, v90
    v_dot2c_f32_bf16 v37, s7, v90
    v_dot2c_f32_bf16 v38, s6, v92
    v_dot2c_f32_bf16 v39, s7, v92
    v_add_f32 v40, v40, v93
    v_bitop3_b32 v13, v13, v91, v12 bitop3:0xf6
    v_bitop3_b32 v13, v13, v95, v12 bitop3:0xf6
    s_waitcnt vmcnt(6)
    v_dot2c_f32_bf16 v32, s6, v96
    v_dot2c_f32_bf16 v33, s7, v96
    v_dot2c_f32_bf16 v34, s6, v97
    v_dot2c_f32_bf16 v35, s7, v97
    v_dot2c_f32_bf16 v36, s6, v98
    v_dot2c_f32_bf16 v37, s7, v98
    v_dot2c_f32_bf16 v38, s6, v100
    v_dot2c_f32_bf16 v39, s7, v100
    v_add_f32 v40, v40, v101
    v_bitop3_b32 v13, v13, v99, v12 bitop3:0xf6
    v_bitop3_b32 v13, v13, v103, v12 bitop3:0xf6
    s_waitcnt vmcnt(4)
    v_dot2c_f32_bf16 v32, s6, v104
    v_dot2c_f32_bf16 v33, s7, v104
    v_dot2c_f32_bf16 v34, s6, v105
    v_dot2c_f32_bf16 v35, s7, v105
    v_dot2c_f32_bf16 v36, s6, v106
    v_dot2c_f32_bf16 v37, s7, v106
    v_dot2c_f32_bf16 v38, s6, v108
    v_dot2c_f32_bf16 v39, s7, v108
    v_add_f32 v40, v40, v109
    v_bitop3_b32 v13, v13, v107, v12 bitop3:0xf6
    v_bitop3_b32 v13, v13, v111, v12 bitop3:0xf6
    s_waitcnt vmcnt(2)
    v_dot2c_f32_bf16 v32, s6, v112
    v_dot2c_f32_bf16 v33, s7, v112
    v_dot2c_f32_bf16 v34, s6, v113
    v_dot2c_f32_bf16 v35, s7, v113
    v_dot2c_f32_bf16 v36, s6, v114
    v_dot2c_f32_bf16 v37, s7, v114
    v_dot2c_f32_bf16 v38, s6, v116
    v_dot2c_f32_bf16 v39, s7, v116
    v_add_f32 v40, v40, v117
    v_bitop3_b32 v13, v13, v115, v12 bitop3:0xf6
    v_bitop3_b32 v13, v13, v119, v12 bitop3:0xf6
    s_waitcnt vmcnt(0)
    v_dot2c_f32_bf16 v32, s6, v120
    v_dot2c_f32_bf16 v33, s7, v120
    v_dot2c_f32_bf16 v34, s6, v121
    v_dot2c_f32_bf16 v35, s7, v121
    v_dot2c_f32_bf16 v36, s6, v122
    v_dot2c_f32_bf16 v37, s7, v122
    v_dot2c_f32_bf16 v38, s6, v124
    v_dot2c_f32_bf16 v39, s7, v124
    v_add_f32 v40, v40, v125
    v_bitop3_b32 v13, v13, v123, v12 bitop3:0xf6
    v_bitop3_b32 v13, v13, v127, v12 bitop3:0xf6
    v_cmp_ne_u32 vcc, 0, v13
    s_cbranch_vccnz PA_12
PAD_14:
    v_cvt_pk_bf16_f32 v44, v32, v33
    v_cvt_pk_bf16_f32 v45, v34, v35
    v_cvt_pk_bf16_f32 v46, v36, v37
    v_cvt_pk_bf16_f32 v47, v38, v39
    v_cvt_pk_bf16_f32 v40, v40, v40
    ds_write_b128 v18, v[44:47]
    ds_write_b16 v19, v40 offset:32
    s_waitcnt lgkmcnt(0)
    s_barrier
    v_and_b32 v14, 15, v1
    v_lshlrev_b32 v14, 6, v14
    s_lshl_b32 s56, s28, 10
    s_add_u32 s56, s56, 1310720
    buffer_load_dword v15, v14, s[24:27], s56 offen sc1
    ds_read_b64_tr_b16 v[64:65], v20 offset:0
    ds_read_b64_tr_b16 v[66:67], v20 offset:256
    ds_read_b64_tr_b16 v[68:69], v20 offset:1024
    ds_read_b64_tr_b16 v[70:71], v20 offset:1280
    ds_read_b64_tr_b16 v[72:73], v20 offset:4096
    ds_read_b64_tr_b16 v[74:75], v20 offset:4352
    ds_read_b64_tr_b16 v[76:77], v20 offset:5120
    ds_read_b64_tr_b16 v[78:79], v20 offset:5376
    ds_read_b64_tr_b16 v[80:81], v20 offset:2048
    ds_read_b64_tr_b16 v[82:83], v20 offset:2304
    ds_read_b64_tr_b16 v[84:85], v20 offset:3072
    ds_read_b64_tr_b16 v[86:87], v20 offset:3328
    ds_read_b64_tr_b16 v[88:89], v20 offset:6144
    ds_read_b64_tr_b16 v[90:91], v20 offset:6400
    ds_read_b64_tr_b16 v[92:93], v20 offset:7168
    ds_read_b64_tr_b16 v[94:95], v20 offset:7424
    s_waitcnt lgkmcnt(14)
    v_mfma_f32_32x32x16_bf16 v[32:47], v[64:67], v[192:195], 0
    s_waitcnt lgkmcnt(12)
    v_mfma_f32_32x32x16_bf16 v[32:47], v[68:71], v[200:203], v[32:47]
    s_waitcnt lgkmcnt(10)
    v_mfma_f32_32x32x16_bf16 v[32:47], v[72:75], v[192:195], v[32:47]
    s_waitcnt lgkmcnt(8)
    v_mfma_f32_32x32x16_bf16 v[32:47], v[76:79], v[200:203], v[32:47]
    s_waitcnt lgkmcnt(6)
    v_mfma_f32_32x32x16_bf16 v[48:63], v[80:83], v[196:199], 0
    s_waitcnt lgkmcnt(4)
    v_mfma_f32_32x32x16_bf16 v[48:63], v[84:87], v[204:207], v[48:63]
    s_waitcnt lgkmcnt(2)
    v_mfma_f32_32x32x16_bf16 v[48:63], v[88:91], v[196:199], v[48:63]
    s_waitcnt lgkmcnt(0)
    v_mfma_f32_32x32x16_bf16 v[48:63], v[92:95], v[204:207], v[48:63]
    s_nop 3
    v_add_f32 v40, 0x358637bd, v40
    v_rcp_f32 v40, v40
    s_nop 0
    v_mul_f32 v32, v32, v40
    v_mul_f32 v33, v33, v40
    v_mul_f32 v34, v34, v40
    v_mul_f32 v35, v35, v40
    v_mul_f32 v36, v36, v40
    v_mul_f32 v37, v37, v40
    v_mul_f32 v38, v38, v40
    v_mul_f32 v39, v39, v40
    v_cvt_pk_bf16_f32 v44, v32, v33
    v_cvt_pk_bf16_f32 v45, v34, v35
    v_cvt_pk_bf16_f32 v46, v36, v37
    v_cvt_pk_bf16_f32 v47, v38, v39
    buffer_store_dwordx4 v[44:47], v3, s[24:27], s93 offen offset:0 sc1
    v_add_f32 v56, 0x358637bd, v56
    v_rcp_f32 v56, v56
    s_nop 0
    v_mul_f32 v48, v48, v56
    v_mul_f32 v49, v49, v56
    v_mul_f32 v50, v50, v56
    v_mul_f32 v51, v51, v56
    v_mul_f32 v52, v52, v56
    v_mul_f32 v53, v53, v56
    v_mul_f32 v54, v54, v56
    v_mul_f32 v55, v55, v56
    v_cvt_pk_bf16_f32 v60, v48, v49
    v_cvt_pk_bf16_f32 v61, v50, v51
    v_cvt_pk_bf16_f32 v62, v52, v53
    v_cvt_pk_bf16_f32 v63, v54, v55
    buffer_store_dwordx4 v[60:63], v3, s[24:27], s93 offen offset:1024 sc1
    v_and_b32 v255, 1, v1
    v_lshlrev_b32 v255, 4, v255
    v_bfe_u32 v18, v1, 1, 1
    v_lshl_add_u32 v255, v18, 3, v255
    v_mul_u32_u24 v19, 192, v21
    v_add_u32 v255, v255, v19
    v_bfe_u32 v19, v1, 4, 1
    v_mul_u32_u24 v19, 3104, v19
    v_add_u32 v255, v255, v19
    s_min_u32 s6, s30, 2
    s_and_b32 s4, s28, 1
    s_mul_i32 s4, s4, 3
    s_add_u32 s6, s6, s4
    s_lshl_b32 s5, s6, 5
    s_add_u32 s5, s5, 76800
    v_add_u32 v21, s5, v255
    v_and_b32 v22, 1, v1
    v_xor_b32 v22, 1, v22
    v_lshlrev_b32 v22, 7, v22
    v_lshl_add_u32 v22, v6, 4, v22
    v_add_u32 v22, 163072, v22
    ds_read_b128 v[128:131], v22 offset:0
    ds_read_b64_tr_b16 v[144:145], v21 offset:0
    ds_read_b64_tr_b16 v[146:147], v21 offset:768
    ds_read_b128 v[132:135], v22 offset:32
    ds_read_b64_tr_b16 v[148:149], v21 offset:6400
    ds_read_b64_tr_b16 v[150:151], v21 offset:7168
    ds_read_b128 v[136:139], v22 offset:64
    ds_read_b64_tr_b16 v[152:153], v21 offset:12800
    ds_read_b64_tr_b16 v[154:155], v21 offset:13568
    ds_read_b128 v[140:143], v22 offset:96
    ds_read_b64_tr_b16 v[156:157], v21 offset:19200
    ds_read_b64_tr_b16 v[158:159], v21 offset:19968
    s_lshr_b32 s3, s28, 1
    s_add_u32 s3, s3, 1
    s_and_b32 s3, s3, 7
    s_mul_i32 s3, s3, 176128
    s_add_u32 s3, s3, s58
    s_add_u32 m0, s59, 102400
    s_nop 0
    buffer_load_dwordx4 v252, s[40:43], s3 offen lds
    s_add_u32 m0, s59, 103424
    s_nop 0
    buffer_load_dwordx4 v253, s[40:43], s3 offen lds
    s_add_u32 m0, s59, 104448
    s_nop 0
    buffer_load_dwordx4 v254, s[40:43], s3 offen lds
    s_add_u32 m0, s59, 105504
    s_nop 0
    buffer_load_dwordx4 v252, s[44:47], s3 offen lds
    s_add_u32 m0, s59, 106528
    s_nop 0
    buffer_load_dwordx4 v253, s[44:47], s3 offen lds
    s_add_u32 m0, s59, 107552
    s_nop 0
    buffer_load_dwordx4 v254, s[44:47], s3 offen lds
    s_waitcnt lgkmcnt(9)
    v_mfma_f32_32x32x16_bf16 v[160:175], v[128:131], v[144:147], 0
    s_waitcnt lgkmcnt(6)
    v_mfma_f32_32x32x16_bf16 v[160:175], v[132:135], v[148:151], v[160:175]
    s_waitcnt lgkmcnt(3)
    v_mfma_f32_32x32x16_bf16 v[160:175], v[136:139], v[152:155], v[160:175]
    s_waitcnt lgkmcnt(0)
    v_mfma_f32_32x32x16_bf16 v[160:175], v[140:143], v[156:159], v[160:175]
    s_lshl_b32 s5, s34, 7
    s_add_u32 s5, s5, 161792
    v_lshlrev_b32 v23, 5, v6
    v_add_u32 v23, s5, v23
    ds_read_b128 v[192:195], v23 offset:0
    ds_read_b128 v[196:199], v23 offset:16
    ds_read_b128 v[200:203], v23 offset:64
    ds_read_b128 v[204:207], v23 offset:80
    ds_read_b128 v[208:211], v23 offset:256
    ds_read_b128 v[212:215], v23 offset:272
    ds_read_b128 v[216:219], v23 offset:320
    ds_read_b128 v[220:223], v23 offset:336
    s_lshl_b32 s5, s29, 3
    s_lshr_b32 s4, s28, 1
    s_add_u32 s5, s5, s4
    s_mul_i32 s5, s5, 3072
    s_lshl_b32 s4, s6, 9
    s_add_u32 s5, s5, s4
    s_add_u32 s5, s5, 1703936
    v_accvgpr_read_b32 v96, a0
    v_accvgpr_read_b32 v97, a1
    v_accvgpr_read_b32 v98, a2
    v_accvgpr_read_b32 v99, a3
    v_accvgpr_read_b32 v100, a4
    v_accvgpr_read_b32 v101, a5
    v_accvgpr_read_b32 v102, a6
    v_accvgpr_read_b32 v103, a7
    v_mov_b32 v162, s65
    v_mov_b32 v163, s65
    s_mov_b64 exec, 0xffffffff
    buffer_store_dwordx4 v[160:163], v3, s[24:27], s5 offen sc1
    s_mov_b64 exec, -1
    s_lshl_b32 s4, s60, 15
    s_lshl_b32 s3, s30, 13
    s_add_u32 s4, s4, s3
    s_add_u32 s4, s4, 6291456
    s_add_u32 s6, s4, 4096
    s_lshl_b32 s5, s61, 15
    s_lshl_b32 s3, s30, 13
    s_add_u32 s5, s5, s3
    s_add_u32 s5, s5, 6291456
    s_add_u32 s7, s5, 4096
    s_xor_b32 s3, s30, 1
    s_mul_i32 s3, s3, 12288
    s_add_u32 s3, s3, 0
    v_add_u32 v16, s3, v3
    s_xor_b32 s3, s30, 2
    s_mul_i32 s3, s3, 12288
    s_add_u32 s3, s3, 4096
    v_add_u32 v17, s3, v3
    s_xor_b32 s3, s30, 3
    s_mul_i32 s3, s3, 12288
    s_add_u32 s3, s3, 8192
    v_add_u32 v18, s3, v3
    s_mul_i32 s3, s30, 12288
    v_add_u32 v19, s3, v3
    s_lshl_b32 s8, s60, 15
    s_lshl_b32 s9, s62, 11
    s_add_u32 s8, s8, s9
    s_add_u32 s8, s8, 8388608
    s_lshl_b32 s9, s62, 14
    s_lshl_b32 s3, s60, 7
    s_add_u32 s9, s9, s3
    s_add_u32 s9, s9, 12582912
    s_waitcnt vmcnt(9)
    v_cmp_ne_u32 vcc, v15, v12
    s_cbranch_vccnz PD_15
PDD_16:
    v_lshlrev_b32 v104, 16, v96
    v_and_b32 v105, 0xffff0000, v96
    v_lshlrev_b32 v106, 16, v97
    v_and_b32 v107, 0xffff0000, v97
    v_lshlrev_b32 v108, 16, v98
    v_and_b32 v109, 0xffff0000, v98
    v_lshlrev_b32 v110, 16, v99
    v_and_b32 v111, 0xffff0000, v99
    v_lshlrev_b32 v112, 16, v100
    v_and_b32 v113, 0xffff0000, v100
    v_lshlrev_b32 v114, 16, v101
    v_and_b32 v115, 0xffff0000, v101
    v_lshlrev_b32 v116, 16, v102
    v_and_b32 v117, 0xffff0000, v102
    v_lshlrev_b32 v118, 16, v103
    v_and_b32 v119, 0xffff0000, v103
    s_mul_i32 s56, s11, 86
    s_add_u32 s56, s56, s10
    s_lshl_b32 s56, s56, 10
    s_add_u32 s56, s56, 13631488
    s_add_u32 s92, s56, 4096
    s_and_b32 s35, s10, 15
    s_cmp_eq_u32 s35, 12
    s_cselect_b32 s35, 0x7f000000, s92
    buffer_store_dwordx4 v[248:251], v3, s[24:27], s56 offen offset:0 sc1
    buffer_store_dwordx4 v[248:251], v3, s[24:27], s56 offen offset:1024 sc1
    buffer_store_dwordx4 v[248:251], v3, s[24:27], s56 offen offset:2048 sc1
    buffer_store_dwordx4 v[248:251], v3, s[24:27], s56 offen offset:3072 sc1
    buffer_store_dwordx4 v[248:251], v3, s[24:27], s35 offen offset:0 sc1
    buffer_store_dwordx4 v[248:251], v3, s[24:27], s35 offen offset:1024 sc1
    buffer_load_dwordx4 v[128:131], v3, s[24:27], s4 offen offset:0 sc1
    buffer_load_dwordx4 v[132:135], v3, s[24:27], s5 offen offset:0 sc1
    buffer_load_dwordx4 v[136:139], v3, s[24:27], s4 offen offset:1024 sc1
    buffer_load_dwordx4 v[140:143], v3, s[24:27], s5 offen offset:1024 sc1
    buffer_load_dwordx4 v[144:147], v3, s[24:27], s4 offen offset:2048 sc1
    buffer_load_dwordx4 v[148:151], v3, s[24:27], s5 offen offset:2048 sc1
    buffer_load_dwordx4 v[152:155], v3, s[24:27], s4 offen offset:3072 sc1
    buffer_load_dwordx4 v[156:159], v3, s[24:27], s5 offen offset:3072 sc1
    buffer_load_dwordx4 v[160:163], v3, s[24:27], s6 offen offset:0 sc1
    buffer_load_dwordx4 v[164:167], v3, s[24:27], s7 offen offset:0 sc1
    buffer_load_dwordx4 v[168:171], v3, s[24:27], s6 offen offset:1024 sc1
    buffer_load_dwordx4 v[172:175], v3, s[24:27], s7 offen offset:1024 sc1
    buffer_load_dwordx4 v[176:179], v3, s[24:27], s6 offen offset:2048 sc1
    buffer_load_dwordx4 v[180:183], v3, s[24:27], s7 offen offset:2048 sc1
    buffer_load_dwordx4 v[184:187], v3, s[24:27], s6 offen offset:3072 sc1
    buffer_load_dwordx4 v[188:191], v3, s[24:27], s7 offen offset:3072 sc1
    s_waitcnt vmcnt(12)
    v_max3_u32 v13, v128, v132, v136
    v_max_u32 v13, v13, v140
    v_cmp_eq_u32 vcc, -1, v13
    s_cbranch_vccnz RT_17
BK_18:
    v_mfma_f32_32x32x16_bf16 v[32:47], a[176:179], v[128:131], 0
    s_lshr_b32 s3, s28, 1
    s_add_u32 s3, s3, 2
    v_mfma_f32_32x32x16_bf16 v[48:63], a[176:179], v[132:135], 0
    s_and_b32 s3, s3, 7
    s_mul_i32 s3, s3, 176128
    v_mfma_f32_32x32x16_bf16 v[64:79], a[180:183], v[128:131], 0
    s_add_u32 s3, s3, s58
    s_add_u32 m0, s59, 128000
    v_mfma_f32_32x32x16_bf16 v[80:95], a[180:183], v[132:135], 0
    buffer_load_dwordx4 v252, s[40:43], s3 offen lds
    s_add_u32 m0, s59, 129024
    v_mfma_f32_32x32x16_bf16 v[32:47], a[184:187], v[136:139], v[32:47]
    buffer_load_dwordx4 v253, s[40:43], s3 offen lds
    s_add_u32 m0, s59, 130048
    v_mfma_f32_32x32x16_bf16 v[48:63], a[184:187], v[140:143], v[48:63]
    buffer_load_dwordx4 v254, s[40:43], s3 offen lds
    s_add_u32 m0, s59, 131104
    v_mfma_f32_32x32x16_bf16 v[64:79], a[188:191], v[136:139], v[64:79]
    buffer_load_dwordx4 v252, s[44:47], s3 offen lds
    s_add_u32 m0, s59, 132128
    v_mfma_f32_32x32x16_bf16 v[80:95], a[188:191], v[140:143], v[80:95]
    buffer_load_dwordx4 v253, s[44:47], s3 offen lds
    s_add_u32 m0, s59, 133152
    s_waitcnt vmcnt(13)
    v_max3_u32 v13, v144, v148, v152
    v_max_u32 v13, v13, v156
    v_cmp_eq_u32 vcc, -1, v13
    s_cbranch_vccnz RT_19
BK_20:
    v_mfma_f32_32x32x16_bf16 v[32:47], a[192:195], v[144:147], v[32:47]
    buffer_load_dwordx4 v254, s[44:47], s3 offen lds
    v_mfma_f32_32x32x16_bf16 v[48:63], a[192:195], v[148:151], v[48:63]
    v_mfma_f32_32x32x16_bf16 v[64:79], a[196:199], v[144:147], v[64:79]
    v_mfma_f32_32x32x16_bf16 v[80:95], a[196:199], v[148:151], v[80:95]
    v_mfma_f32_32x32x16_bf16 v[32:47], a[200:203], v[152:155], v[32:47]
    v_mfma_f32_32x32x16_bf16 v[48:63], a[200:203], v[156:159], v[48:63]
    v_mfma_f32_32x32x16_bf16 v[64:79], a[204:207], v[152:155], v[64:79]
    v_mfma_f32_32x32x16_bf16 v[80:95], a[204:207], v[156:159], v[80:95]
    s_waitcnt vmcnt(10)
    v_max3_u32 v13, v160, v164, v168
    v_max_u32 v13, v13, v172
    v_cmp_eq_u32 vcc, -1, v13
    s_cbranch_vccnz RT_21
BK_22:
    v_mfma_f32_32x32x16_bf16 v[32:47], a[208:211], v[160:163], v[32:47]
    v_mfma_f32_32x32x16_bf16 v[48:63], a[208:211], v[164:167], v[48:63]
    v_mfma_f32_32x32x16_bf16 v[64:79], a[212:215], v[160:163], v[64:79]
    v_mfma_f32_32x32x16_bf16 v[80:95], a[212:215], v[164:167], v[80:95]
    v_mfma_f32_32x32x16_bf16 v[32:47], a[216:219], v[168:171], v[32:47]
    v_mfma_f32_32x32x16_bf16 v[48:63], a[216:219], v[172:175], v[48:63]
    v_mfma_f32_32x32x16_bf16 v[64:79], a[220:223], v[168:171], v[64:79]
    v_mfma_f32_32x32x16_bf16 v[80:95], a[220:223], v[172:175], v[80:95]
    s_waitcnt vmcnt(6)
    v_max3_u32 v13, v176, v180, v184
    v_max_u32 v13, v13, v188
    v_cmp_eq_u32 vcc, -1, v13
    s_cbranch_vccnz RT_23
BK_24:
    v_mfma_f32_32x32x16_bf16 v[80:95], a[228:231], v[180:183], v[80:95]
    v_mfma_f32_32x32x16_bf16 v[80:95], a[236:239], v[188:191], v[80:95]
    v_mfma_f32_32x32x16_bf16 v[64:79], a[228:231], v[176:179], v[64:79]
    v_mfma_f32_32x32x16_bf16 v[64:79], a[236:239], v[184:187], v[64:79]
    v_mfma_f32_32x32x16_bf16 v[48:63], a[224:227], v[180:183], v[48:63]
    v_mfma_f32_32x32x16_bf16 v[48:63], a[232:235], v[188:191], v[48:63]
    s_nop 7
    ds_write_b128 v18, v[80:83] offset:0
    ds_write_b128 v18, v[84:87] offset:1024
    ds_write_b128 v18, v[88:91] offset:2048
    ds_write_b128 v18, v[92:95] offset:3072
    v_mfma_f32_32x32x16_bf16 v[32:47], a[224:227], v[176:179], v[32:47]
    v_mfma_f32_32x32x16_bf16 v[32:47], a[232:235], v[184:187], v[32:47]
    ds_write_b128 v17, v[64:67] offset:0
    ds_write_b128 v17, v[68:71] offset:1024
    ds_write_b128 v17, v[72:75] offset:2048
    ds_write_b128 v17, v[76:79] offset:3072
    ds_write_b128 v16, v[48:51] offset:0
    ds_write_b128 v16, v[52:55] offset:1024
    ds_write_b128 v16, v[56:59] offset:2048
    ds_write_b128 v16, v[60:63] offset:3072
    s_waitcnt lgkmcnt(0)
    s_barrier
    ds_read_b128 v[128:131], v19 offset:0
    ds_read_b128 v[132:135], v19 offset:1024
    ds_read_b128 v[136:139], v19 offset:2048
    ds_read_b128 v[140:143], v19 offset:3072
    ds_read_b128 v[144:147], v19 offset:4096
    ds_read_b128 v[148:151], v19 offset:5120
    ds_read_b128 v[152:155], v19 offset:6144
    ds_read_b128 v[156:159], v19 offset:7168
    ds_read_b128 v[160:163], v19 offset:8192
    ds_read_b128 v[164:167], v19 offset:9216
    ds_read_b128 v[168:171], v19 offset:10240
    ds_read_b128 v[172:175], v19 offset:11264
    s_waitcnt lgkmcnt(11)
    v_add_f32 v32, v32, v128
    v_add_f32 v33, v33, v129
    v_add_f32 v34, v34, v130
    v_add_f32 v35, v35, v131
    s_waitcnt lgkmcnt(10)
    v_add_f32 v36, v36, v132
    v_add_f32 v37, v37, v133
    v_add_f32 v38, v38, v134
    v_add_f32 v39, v39, v135
    s_waitcnt lgkmcnt(9)
    v_add_f32 v40, v40, v136
    v_add_f32 v41, v41, v137
    v_add_f32 v42, v42, v138
    v_add_f32 v43, v43, v139
    s_waitcnt lgkmcnt(8)
    v_add_f32 v44, v44, v140
    v_add_f32 v45, v45, v141
    v_add_f32 v46, v46, v142
    v_add_f32 v47, v47, v143
    s_waitcnt lgkmcnt(7)
    v_add_f32 v32, v32, v144
    v_add_f32 v33, v33, v145
    v_add_f32 v34, v34, v146
    v_add_f32 v35, v35, v147
    s_waitcnt lgkmcnt(6)
    v_add_f32 v36, v36, v148
    v_add_f32 v37, v37, v149
    v_add_f32 v38, v38, v150
    v_add_f32 v39, v39, v151
    s_waitcnt lgkmcnt(5)
    v_add_f32 v40, v40, v152
    v_add_f32 v41, v41, v153
    v_add_f32 v42, v42, v154
    v_add_f32 v43, v43, v155
    s_waitcnt lgkmcnt(4)
    v_add_f32 v44, v44, v156
    v_add_f32 v45, v45, v157
    v_add_f32 v46, v46, v158
    v_add_f32 v47, v47, v159
    s_waitcnt lgkmcnt(3)
    v_add_f32 v32, v32, v160
    v_add_f32 v33, v33, v161
    v_add_f32 v34, v34, v162
    v_add_f32 v35, v35, v163
    s_waitcnt lgkmcnt(2)
    v_add_f32 v36, v36, v164
    v_add_f32 v37, v37, v165
    v_add_f32 v38, v38, v166
    v_add_f32 v39, v39, v167
    s_waitcnt lgkmcnt(1)
    v_add_f32 v40, v40, v168
    v_add_f32 v41, v41, v169
    v_add_f32 v42, v42, v170
    v_add_f32 v43, v43, v171
    s_waitcnt lgkmcnt(0)
    v_add_f32 v44, v44, v172
    v_add_f32 v45, v45, v173
    v_add_f32 v46, v46, v174
    v_add_f32 v47, v47, v175
    v_fma_f32 v176, v32, v192, v104
    v_fma_f32 v177, v33, v193, v105
    v_fma_f32 v178, v34, v194, v106
    v_fma_f32 v179, v35, v195, v107
    v_fma_f32 v180, v36, v196, v108
    v_fma_f32 v181, v37, v197, v109
    v_fma_f32 v182, v38, v198, v110
    v_fma_f32 v183, v39, v199, v111
    v_fma_f32 v184, v40, v200, v112
    v_fma_f32 v185, v41, v201, v113
    v_fma_f32 v186, v42, v202, v114
    v_fma_f32 v187, v43, v203, v115
    v_fma_f32 v188, v44, v204, v116
    v_fma_f32 v189, v45, v205, v117
    v_fma_f32 v190, v46, v206, v118
    v_fma_f32 v191, v47, v207, v119
    v_mul_f32 v104, v176, v208
    v_mul_f32 v105, v177, v209
    v_mul_f32 v106, v178, v210
    v_mul_f32 v107, v179, v211
    v_mul_f32 v108, v180, v212
    v_mul_f32 v109, v181, v213
    v_mul_f32 v110, v182, v214
    v_mul_f32 v111, v183, v215
    v_mul_f32 v112, v184, v216
    v_mul_f32 v113, v185, v217
    v_mul_f32 v114, v186, v218
    v_mul_f32 v115, v187, v219
    v_mul_f32 v116, v188, v220
    v_mul_f32 v117, v189, v221
    v_mul_f32 v118, v190, v222
    v_mul_f32 v119, v191, v223
    v_cvt_pk_bf16_f32 v64, v104, v105
    v_cvt_pk_bf16_f32 v65, v106, v107
    v_cvt_pk_bf16_f32 v66, v108, v109
    v_cvt_pk_bf16_f32 v67, v110, v111
    v_cvt_pk_bf16_f32 v68, v112, v113
    v_cvt_pk_bf16_f32 v69, v114, v115
    v_cvt_pk_bf16_f32 v70, v116, v117
    v_cvt_pk_bf16_f32 v71, v118, v119
    buffer_store_dwordx4 v[64:67], v3, s[24:27], s8 offen offset:0 sc1
    buffer_store_dwordx4 v[68:71], v3, s[24:27], s8 offen offset:1024 sc1
    v_add_f32 v72, v176, v177
    v_mul_f32 v74, v176, v176
    v_add_f32 v73, v178, v179
    v_mul_f32 v75, v177, v177
    v_fmac_f32 v74, v178, v178
    v_fmac_f32 v75, v179, v179
    v_add_f32 v72, v72, v180
    v_fmac_f32 v74, v180, v180
    v_add_f32 v73, v73, v181
    v_fmac_f32 v75, v181, v181
    v_add_f32 v72, v72, v182
    v_fmac_f32 v74, v182, v182
    v_add_f32 v73, v73, v183
    v_fmac_f32 v75, v183, v183
    v_add_f32 v72, v72, v184
    v_fmac_f32 v74, v184, v184
    v_add_f32 v73, v73, v185
    v_fmac_f32 v75, v185, v185
    v_add_f32 v72, v72, v186
    v_fmac_f32 v74, v186, v186
    v_add_f32 v73, v73, v187
    v_fmac_f32 v75, v187, v187
    v_add_f32 v72, v72, v188
    v_fmac_f32 v74, v188, v188
    v_add_f32 v73, v73, v189
    v_fmac_f32 v75, v189, v189
    v_add_f32 v72, v72, v190
    v_fmac_f32 v74, v190, v190
    v_add_f32 v73, v73, v191
    v_fmac_f32 v75, v191, v191
    v_add_f32 v72, v72, v73
    v_add_f32 v74, v74, v75
    s_nop 1
    v_permlane32_swap_b32 v72, v74
    v_add_f32 v72, v72, v74
    buffer_store_dword v72, v4, s[24:27], s9 offen sc1
    v_min_u32 v11, 191, v0
    v_lshlrev_b32 v9, 3, v11
    v_add_u32 v9, 157696, v9
    v_lshlrev_b32 v11, 4, v11
    s_mul_i32 s9, s29, 24576
    s_add_u32 s9, s9, 1703936
    s_add_u32 s3, s9, 0
    buffer_load_dwordx3 v[80:82], v11, s[24:27], s3 offen sc1
    s_add_u32 s3, s9, 3072
    buffer_load_dwordx3 v[84:86], v11, s[24:27], s3 offen sc1
    s_add_u32 s3, s9, 6144
    buffer_load_dwordx3 v[88:90], v11, s[24:27], s3 offen sc1
    s_add_u32 s3, s9, 9216
    buffer_load_dwordx3 v[92:94], v11, s[24:27], s3 offen sc1
    s_add_u32 s3, s9, 12288
    buffer_load_dwordx3 v[96:98], v11, s[24:27], s3 offen sc1
    s_add_u32 s3, s9, 15360
    buffer_load_dwordx3 v[100:102], v11, s[24:27], s3 offen sc1
    s_add_u32 s3, s9, 18432
    buffer_load_dwordx3 v[104:106], v11, s[24:27], s3 offen sc1
    s_add_u32 s3, s9, 21504
    buffer_load_dwordx3 v[108:110], v11, s[24:27], s3 offen sc1
    s_lshr_b32 s3, s28, 1
    s_add_u32 s3, s3, 3
    s_and_b32 s3, s3, 7
    s_mul_i32 s3, s3, 176128
    s_add_u32 s3, s3, s58
    s_add_u32 m0, s59, 51200
    s_nop 0
    buffer_load_dwordx4 v252, s[40:43], s3 offen lds
    s_add_u32 m0, s59, 52224
    s_nop 0
    buffer_load_dwordx4 v253, s[40:43], s3 offen lds
    s_add_u32 m0, s59, 53248
    s_nop 0
    buffer_load_dwordx4 v254, s[40:43], s3 offen lds
    s_add_u32 m0, s59, 54304
    s_nop 0
    buffer_load_dwordx4 v252, s[44:47], s3 offen lds
    s_add_u32 m0, s59, 55328
    s_nop 0
    buffer_load_dwordx4 v253, s[44:47], s3 offen lds
    s_add_u32 m0, s59, 56352
    s_nop 0
    buffer_load_dwordx4 v254, s[44:47], s3 offen lds
    v_add_u32 v250, 0xc800, v255
    v_add_u32 v251, 0x19000, v255
    v_and_b32 v8, 31, v1
    v_lshlrev_b32 v8, 3, v8
    v_add_u32 v8, 157696, v8
    s_lshl_b32 s4, s11, 15
    s_add_u32 s6, s4, 8388608
    s_lshl_b32 s7, s11, 7
    s_add_u32 s7, s7, 12582912
    s_lshr_b32 s8, s28, 1
    v_lshrrev_b32 v10, 3, v1
    v_lshlrev_b32 v10, 13, v10
    v_and_b32 v14, 7, v1
    v_lshl_add_u32 v10, v14, 4, v10
    v_lshlrev_b32 v14, 4, v14
    v_lshl_add_u32 v14, v6, 3, v14
    v_bfe_u32 v15, v1, 4, 1
    v_lshl_add_u32 v14, v15, 2, v14
    v_bfe_u32 v15, v1, 3, 1
    v_lshl_add_u32 v14, v15, 7, v14
    s_lshl_b32 s4, s30, 8
    s_add_u32 s4, s4, 153600
    v_add_u32 v14, s4, v14
    v_and_b32 v15, 31, v1
    v_lshlrev_b32 v15, 2, v15
    v_add_u32 v15, s4, v15
    v_accvgpr_write_b32 a178, 0
    v_accvgpr_write_b32 a179, 0
    v_accvgpr_write_b32 a182, 0
    v_accvgpr_write_b32 a183, 0
    v_accvgpr_write_b32 a186, 0
    v_accvgpr_write_b32 a187, 0
    v_accvgpr_write_b32 a190, 0
    v_accvgpr_write_b32 a191, 0
    v_accvgpr_write_b32 a194, 0
    v_accvgpr_write_b32 a195, 0
    v_accvgpr_write_b32 a198, 0
    v_accvgpr_write_b32 a199, 0
    s_mul_i32 s64, s30, 22
    s_cmp_eq_u32 s30, 3
    s_cselect_b32 s64, 65, s64
    s_lshl_b32 s92, s64, 14
    s_lshl_b32 s3, s31, 7
    s_add_u32 s92, s92, s3
    s_mul_i32 s35, s30, 6144
PUC_26:
    v_mov_b32 v126, 0
    v_mov_b32 v127, 0
    v_mov_b32 v123, 0
    s_waitcnt vmcnt(13)
    v_add_f32 v126, v126, v80
    v_add_f32 v127, v127, v81
    v_bitop3_b32 v123, v123, v82, v12 bitop3:0xf6
    s_waitcnt vmcnt(12)
    v_add_f32 v126, v126, v84
    v_add_f32 v127, v127, v85
    v_bitop3_b32 v123, v123, v86, v12 bitop3:0xf6
    s_waitcnt vmcnt(11)
    v_add_f32 v126, v126, v88
    v_add_f32 v127, v127, v89
    v_bitop3_b32 v123, v123, v90, v12 bitop3:0xf6
    s_waitcnt vmcnt(10)
    v_add_f32 v126, v126, v92
    v_add_f32 v127, v127, v93
    v_bitop3_b32 v123, v123, v94, v12 bitop3:0xf6
    s_waitcnt vmcnt(9)
    v_add_f32 v126, v126, v96
    v_add_f32 v127, v127, v97
    v_bitop3_b32 v123, v123, v98, v12 bitop3:0xf6
    s_waitcnt vmcnt(8)
    v_add_f32 v126, v126, v100
    v_add_f32 v127, v127, v101
    v_bitop3_b32 v123, v123, v102, v12 bitop3:0xf6
    s_waitcnt vmcnt(7)
    v_add_f32 v126, v126, v104
    v_add_f32 v127, v127, v105
    v_bitop3_b32 v123, v123, v106, v12 bitop3:0xf6
    s_waitcnt vmcnt(6)
    v_add_f32 v126, v126, v108
    v_add_f32 v127, v127, v109
    v_bitop3_b32 v123, v123, v110, v12 bitop3:0xf6
    v_cmp_ne_u32 vcc, 0, v123
    s_cbranch_vccnz PU_25
PUD_27:
    v_cvt_pk_bf16_f32 v120, v126, v127
    v_lshlrev_b32 v121, 16, v120
    v_and_b32 v122, 0xffff0000, v120
    v_sub_f32 v126, v126, v121
    v_sub_f32 v127, v127, v122
    v_cvt_pk_bf16_f32 v124, v121, v126
    v_cvt_pk_bf16_f32 v125, v122, v127
    ds_write_b64 v9, v[124:125]
    s_add_u32 s4, s8, 0
    s_and_b32 s4, s4, 7
    s_lshl_b32 s4, s4, 12
    s_add_u32 s4, s4, s6
    buffer_load_dwordx4 v[32:35], v3, s[24:27], s4 offen offset:0 sc1
    buffer_load_dwordx4 v[36:39], v3, s[24:27], s4 offen offset:1024 sc1
    buffer_load_dwordx4 v[40:43], v3, s[24:27], s4 offen offset:2048 sc1
    buffer_load_dwordx4 v[44:47], v3, s[24:27], s4 offen offset:3072 sc1
    s_add_u32 s4, s8, 1
    s_and_b32 s4, s4, 7
    s_lshl_b32 s4, s4, 12
    s_add_u32 s4, s4, s6
    buffer_load_dwordx4 v[48:51], v3, s[24:27], s4 offen offset:0 sc1
    buffer_load_dwordx4 v[52:55], v3, s[24:27], s4 offen offset:1024 sc1
    buffer_load_dwordx4 v[56:59], v3, s[24:27], s4 offen offset:2048 sc1
    buffer_load_dwordx4 v[60:63], v3, s[24:27], s4 offen offset:3072 sc1
    s_add_u32 s4, s8, 2
    s_and_b32 s4, s4, 7
    s_lshl_b32 s4, s4, 12
    s_add_u32 s4, s4, s6
    buffer_load_dwordx4 v[160:163], v3, s[24:27], s4 offen offset:0 sc1
    buffer_load_dwordx4 v[164:167], v3, s[24:27], s4 offen offset:1024 sc1
    buffer_load_dwordx4 v[168:171], v3, s[24:27], s4 offen offset:2048 sc1
    buffer_load_dwordx4 v[172:175], v3, s[24:27], s4 offen offset:3072 sc1
    s_barrier
    ds_read_b64_tr_b16 a[0:1], v250 offset:25600
    ds_read_b64_tr_b16 a[2:3], v250 offset:26368
    ds_read_b64_tr_b16 a[4:5], v250 offset:25632
    ds_read_b64_tr_b16 a[6:7], v250 offset:26400
    ds_read_b64_tr_b16 a[8:9], v250 offset:25664
    ds_read_b64_tr_b16 a[10:11], v250 offset:26432
    ds_read_b64_tr_b16 a[12:13], v250 offset:25696
    ds_read_b64_tr_b16 a[14:15], v250 offset:26464
    ds_read_b64_tr_b16 a[16:17], v250 offset:25728
    ds_read_b64_tr_b16 a[18:19], v250 offset:26496
    ds_read_b64_tr_b16 a[20:21], v250 offset:25760
    ds_read_b64_tr_b16 a[22:23], v250 offset:26528
    s_waitcnt vmcnt(8)
    v_max3_u32 v13, v32, v36, v40
    v_max_u32 v13, v13, v44
    v_cmp_eq_u32 vcc, -1, v13
    s_cbranch_vccnz RT_28
BK_29:
    s_waitcnt lgkmcnt(10)
    v_mfma_f32_32x32x16_bf16 v[64:79], a[0:3], v[32:35], 0
    ds_read_b64_tr_b16 a[24:25], v250 offset:32000
    ds_read_b64_tr_b16 a[26:27], v250 offset:32768
    s_lshr_b32 s3, s28, 1
    s_add_u32 s3, s3, 4
    s_waitcnt lgkmcnt(10)
    v_mfma_f32_32x32x16_bf16 v[80:95], a[4:7], v[32:35], 0
    ds_read_b64_tr_b16 a[28:29], v250 offset:32032
    ds_read_b64_tr_b16 a[30:31], v250 offset:32800
    s_and_b32 s3, s3, 7
    s_mul_i32 s3, s3, 176128
    s_waitcnt lgkmcnt(10)
    v_mfma_f32_32x32x16_bf16 v[96:111], a[8:11], v[32:35], 0
    ds_read_b64_tr_b16 a[32:33], v250 offset:32064
    ds_read_b64_tr_b16 a[34:35], v250 offset:32832
    s_add_u32 s3, s3, s58
    s_add_u32 m0, s59, 0
    s_waitcnt lgkmcnt(10)
    v_mfma_f32_32x32x16_bf16 v[112:127], a[12:15], v[32:35], 0
    ds_read_b64_tr_b16 a[36:37], v250 offset:32096
    ds_read_b64_tr_b16 a[38:39], v250 offset:32864
    buffer_load_dwordx4 v252, s[40:43], s3 offen lds
    s_add_u32 m0, s59, 1024
    s_waitcnt lgkmcnt(10)
    v_mfma_f32_32x32x16_bf16 v[128:143], a[16:19], v[32:35], 0
    ds_read_b64_tr_b16 a[40:41], v250 offset:32128
    ds_read_b64_tr_b16 a[42:43], v250 offset:32896
    buffer_load_dwordx4 v253, s[40:43], s3 offen lds
    s_add_u32 m0, s59, 2048
    s_waitcnt lgkmcnt(10)
    v_mfma_f32_32x32x16_bf16 v[144:159], a[20:23], v[32:35], 0
    ds_read_b64_tr_b16 a[44:45], v250 offset:32160
    ds_read_b64_tr_b16 a[46:47], v250 offset:32928
    buffer_load_dwordx4 v254, s[40:43], s3 offen lds
    s_add_u32 m0, s59, 3104
    s_waitcnt lgkmcnt(10)
    v_mfma_f32_32x32x16_bf16 v[64:79], a[24:27], v[36:39], v[64:79]
    ds_read_b64_tr_b16 a[0:1], v250 offset:38400
    ds_read_b64_tr_b16 a[2:3], v250 offset:39168
    buffer_load_dwordx4 v252, s[44:47], s3 offen lds
    s_add_u32 m0, s59, 4128
    s_waitcnt lgkmcnt(10)
    v_mfma_f32_32x32x16_bf16 v[80:95], a[28:31], v[36:39], v[80:95]
    ds_read_b64_tr_b16 a[4:5], v250 offset:38432
    ds_read_b64_tr_b16 a[6:7], v250 offset:39200
    buffer_load_dwordx4 v253, s[44:47], s3 offen lds
    s_add_u32 m0, s59, 5152
    s_waitcnt lgkmcnt(10)
    v_mfma_f32_32x32x16_bf16 v[96:111], a[32:35], v[36:39], v[96:111]
    ds_read_b64_tr_b16 a[8:9], v250 offset:38464
    ds_read_b64_tr_b16 a[10:11], v250 offset:39232
    buffer_load_dwordx4 v254, s[44:47], s3 offen lds
    s_lshr_b32 s3, s28, 1
    s_waitcnt lgkmcnt(10)
    v_mfma_f32_32x32x16_bf16 v[112:127], a[36:39], v[36:39], v[112:127]
    ds_read_b64_tr_b16 a[12:13], v250 offset:38496
    ds_read_b64_tr_b16 a[14:15], v250 offset:39264
    s_add_u32 s3, s3, 5
    s_and_b32 s3, s3, 7
    s_waitcnt lgkmcnt(10)
    v_mfma_f32_32x32x16_bf16 v[128:143], a[40:43], v[36:39], v[128:143]
    ds_read_b64_tr_b16 a[16:17], v250 offset:38528
    ds_read_b64_tr_b16 a[18:19], v250 offset:39296
    s_mul_i32 s3, s3, 176128
    s_add_u32 s3, s3, s58
    s_waitcnt lgkmcnt(10)
    v_mfma_f32_32x32x16_bf16 v[144:159], a[44:47], v[36:39], v[144:159]
    ds_read_b64_tr_b16 a[20:21], v250 offset:38560
    ds_read_b64_tr_b16 a[22:23], v250 offset:39328
    s_add_u32 m0, s59, 25600
    s_nop 0
    buffer_load_dwordx4 v252, s[40:43], s3 offen lds
    s_waitcnt lgkmcnt(10)
    v_mfma_f32_32x32x16_bf16 v[64:79], a[0:3], v[40:43], v[64:79]
    ds_read_b64_tr_b16 a[24:25], v250 offset:44800
    ds_read_b64_tr_b16 a[26:27], v250 offset:45568
    s_add_u32 m0, s59, 26624
    s_nop 0
    buffer_load_dwordx4 v253, s[40:43], s3 offen lds
    s_waitcnt lgkmcnt(10)
    v_mfma_f32_32x32x16_bf16 v[80:95], a[4:7], v[40:43], v[80:95]
    ds_read_b64_tr_b16 a[28:29], v250 offset:44832
    ds_read_b64_tr_b16 a[30:31], v250 offset:45600
    s_add_u32 m0, s59, 27648
    s_nop 0
    buffer_load_dwordx4 v254, s[40:43], s3 offen lds
    s_waitcnt lgkmcnt(10)
    v_mfma_f32_32x32x16_bf16 v[96:111], a[8:11], v[40:43], v[96:111]
    ds_read_b64_tr_b16 a[32:33], v250 offset:44864
    ds_read_b64_tr_b16 a[34:35], v250 offset:45632
    s_add_u32 m0, s59, 28704
    s_nop 0
    buffer_load_dwordx4 v252, s[44:47], s3 offen lds
    s_waitcnt lgkmcnt(10)
    v_mfma_f32_32x32x16_bf16 v[112:127], a[12:15], v[40:43], v[112:127]
    ds_read_b64_tr_b16 a[36:37], v250 offset:44896
    ds_read_b64_tr_b16 a[38:39], v250 offset:45664
    s_add_u32 m0, s59, 29728
    s_nop 0
    buffer_load_dwordx4 v253, s[44:47], s3 offen lds
    s_waitcnt lgkmcnt(10)
    v_mfma_f32_32x32x16_bf16 v[128:143], a[16:19], v[40:43], v[128:143]
    ds_read_b64_tr_b16 a[40:41], v250 offset:44928
    ds_read_b64_tr_b16 a[42:43], v250 offset:45696
    s_add_u32 m0, s59, 30752
    s_nop 0
    buffer_load_dwordx4 v254, s[44:47], s3 offen lds
    s_waitcnt lgkmcnt(10)
    v_mfma_f32_32x32x16_bf16 v[144:159], a[20:23], v[40:43], v[144:159]
    ds_read_b64_tr_b16 a[44:45], v250 offset:44960
    ds_read_b64_tr_b16 a[46:47], v250 offset:45728
    s_waitcnt lgkmcnt(10)
    v_mfma_f32_32x32x16_bf16 v[64:79], a[24:27], v[44:47], v[64:79]
    ds_read_b64_tr_b16 a[0:1], v251 offset:0
    ds_read_b64_tr_b16 a[2:3], v251 offset:768
    s_waitcnt lgkmcnt(10)
    v_mfma_f32_32x32x16_bf16 v[80:95], a[28:31], v[44:47], v[80:95]
    ds_read_b64_tr_b16 a[4:5], v251 offset:32
    ds_read_b64_tr_b16 a[6:7], v251 offset:800
    s_waitcnt lgkmcnt(10)
    v_mfma_f32_32x32x16_bf16 v[96:111], a[32:35], v[44:47], v[96:111]
    ds_read_b64_tr_b16 a[8:9], v251 offset:64
    ds_read_b64_tr_b16 a[10:11], v251 offset:832
    s_waitcnt lgkmcnt(10)
    v_mfma_f32_32x32x16_bf16 v[112:127], a[36:39], v[44:47], v[112:127]
    ds_read_b64_tr_b16 a[12:13], v251 offset:96
    ds_read_b64_tr_b16 a[14:15], v251 offset:864
    s_waitcnt lgkmcnt(10)
    v_mfma_f32_32x32x16_bf16 v[128:143], a[40:43], v[44:47], v[128:143]
    ds_read_b64_tr_b16 a[16:17], v251 offset:128
    ds_read_b64_tr_b16 a[18:19], v251 offset:896
    s_waitcnt lgkmcnt(10)
    v_mfma_f32_32x32x16_bf16 v[144:159], a[44:47], v[44:47], v[144:159]
    ds_read_b64_tr_b16 a[20:21], v251 offset:160
    ds_read_b64_tr_b16 a[22:23], v251 offset:928
    s_waitcnt vmcnt(16)
    v_max3_u32 v13, v48, v52, v56
    v_max_u32 v13, v13, v60
    v_cmp_eq_u32 vcc, -1, v13
    s_cbranch_vccnz RT_30
BK_31:
    s_waitcnt lgkmcnt(10)
    v_mfma_f32_32x32x16_bf16 v[64:79], a[0:3], v[48:51], v[64:79]
    ds_read_b64_tr_b16 a[24:25], v251 offset:6400
    ds_read_b64_tr_b16 a[26:27], v251 offset:7168
    s_add_u32 s4, s8, 3
    s_and_b32 s4, s4, 7
    s_waitcnt lgkmcnt(10)
    v_mfma_f32_32x32x16_bf16 v[80:95], a[4:7], v[48:51], v[80:95]
    ds_read_b64_tr_b16 a[28:29], v251 offset:6432
    ds_read_b64_tr_b16 a[30:31], v251 offset:7200
    s_waitcnt lgkmcnt(10)
    v_mfma_f32_32x32x16_bf16 v[96:111], a[8:11], v[48:51], v[96:111]
    ds_read_b64_tr_b16 a[32:33], v251 offset:6464
    ds_read_b64_tr_b16 a[34:35], v251 offset:7232
    s_lshl_b32 s4, s4, 12
    s_add_u32 s4, s4, s6
    s_waitcnt lgkmcnt(10)
    v_mfma_f32_32x32x16_bf16 v[112:127], a[12:15], v[48:51], v[112:127]
    ds_read_b64_tr_b16 a[36:37], v251 offset:6496
    ds_read_b64_tr_b16 a[38:39], v251 offset:7264
    s_waitcnt lgkmcnt(10)
    v_mfma_f32_32x32x16_bf16 v[128:143], a[16:19], v[48:51], v[128:143]
    ds_read_b64_tr_b16 a[40:41], v251 offset:6528
    ds_read_b64_tr_b16 a[42:43], v251 offset:7296
    buffer_load_dwordx4 v[32:35], v3, s[24:27], s4 offen offset:0 sc1
    buffer_load_dwordx4 v[36:39], v3, s[24:27], s4 offen offset:1024 sc1
    s_waitcnt lgkmcnt(10)
    v_mfma_f32_32x32x16_bf16 v[144:159], a[20:23], v[48:51], v[144:159]
    ds_read_b64_tr_b16 a[44:45], v251 offset:6560
    ds_read_b64_tr_b16 a[46:47], v251 offset:7328
    s_barrier
    s_waitcnt lgkmcnt(10)
    v_mfma_f32_32x32x16_bf16 v[64:79], a[24:27], v[52:55], v[64:79]
    ds_read_b64_tr_b16 a[0:1], v251 offset:12800
    ds_read_b64_tr_b16 a[2:3], v251 offset:13568
    buffer_load_dwordx4 v[40:43], v3, s[24:27], s4 offen offset:2048 sc1
    buffer_load_dwordx4 v[44:47], v3, s[24:27], s4 offen offset:3072 sc1
    s_waitcnt lgkmcnt(10)
    v_mfma_f32_32x32x16_bf16 v[80:95], a[28:31], v[52:55], v[80:95]
    ds_read_b64_tr_b16 a[4:5], v251 offset:12832
    ds_read_b64_tr_b16 a[6:7], v251 offset:13600
    s_lshr_b32 s3, s28, 1
    s_add_u32 s3, s3, 6
    s_waitcnt lgkmcnt(10)
    v_mfma_f32_32x32x16_bf16 v[96:111], a[32:35], v[52:55], v[96:111]
    ds_read_b64_tr_b16 a[8:9], v251 offset:12864
    ds_read_b64_tr_b16 a[10:11], v251 offset:13632
    s_and_b32 s3, s3, 7
    s_mul_i32 s3, s3, 176128
    s_waitcnt lgkmcnt(10)
    v_mfma_f32_32x32x16_bf16 v[112:127], a[36:39], v[52:55], v[112:127]
    ds_read_b64_tr_b16 a[12:13], v251 offset:12896
    ds_read_b64_tr_b16 a[14:15], v251 offset:13664
    s_add_u32 s3, s3, s58
    s_add_u32 m0, s59, 76800
    s_waitcnt lgkmcnt(10)
    v_mfma_f32_32x32x16_bf16 v[128:143], a[40:43], v[52:55], v[128:143]
    ds_read_b64_tr_b16 a[16:17], v251 offset:12928
    ds_read_b64_tr_b16 a[18:19], v251 offset:13696
    buffer_load_dwordx4 v252, s[40:43], s3 offen lds
    s_add_u32 m0, s59, 77824
    s_waitcnt lgkmcnt(10)
    v_mfma_f32_32x32x16_bf16 v[144:159], a[44:47], v[52:55], v[144:159]
    ds_read_b64_tr_b16 a[20:21], v251 offset:12960
    ds_read_b64_tr_b16 a[22:23], v251 offset:13728
    buffer_load_dwordx4 v253, s[40:43], s3 offen lds
    s_add_u32 m0, s59, 78848
    s_waitcnt lgkmcnt(10)
    v_mfma_f32_32x32x16_bf16 v[64:79], a[0:3], v[56:59], v[64:79]
    ds_read_b64_tr_b16 a[24:25], v251 offset:19200
    ds_read_b64_tr_b16 a[26:27], v251 offset:19968
    buffer_load_dwordx4 v254, s[40:43], s3 offen lds
    s_add_u32 m0, s59, 79904
    s_waitcnt lgkmcnt(10)
    v_mfma_f32_32x32x16_bf16 v[80:95], a[4:7], v[56:59], v[80:95]
    ds_read_b64_tr_b16 a[28:29], v251 offset:19232
    ds_read_b64_tr_b16 a[30:31], v251 offset:20000
    buffer_load_dwordx4 v252, s[44:47], s3 offen lds
    s_add_u32 m0, s59, 80928
    s_waitcnt lgkmcnt(10)
    v_mfma_f32_32x32x16_bf16 v[96:111], a[8:11], v[56:59], v[96:111]
    ds_read_b64_tr_b16 a[32:33], v251 offset:19264
    ds_read_b64_tr_b16 a[34:35], v251 offset:20032
    buffer_load_dwordx4 v253, s[44:47], s3 offen lds
    s_add_u32 m0, s59, 81952
    s_waitcnt lgkmcnt(10)
    v_mfma_f32_32x32x16_bf16 v[112:127], a[12:15], v[56:59], v[112:127]
    ds_read_b64_tr_b16 a[36:37], v251 offset:19296
    ds_read_b64_tr_b16 a[38:39], v251 offset:20064
    buffer_load_dwordx4 v254, s[44:47], s3 offen lds
    s_waitcnt lgkmcnt(10)
    v_mfma_f32_32x32x16_bf16 v[128:143], a[16:19], v[56:59], v[128:143]
    ds_read_b64_tr_b16 a[40:41], v251 offset:19328
    ds_read_b64_tr_b16 a[42:43], v251 offset:20096
    s_waitcnt lgkmcnt(10)
    v_mfma_f32_32x32x16_bf16 v[144:159], a[20:23], v[56:59], v[144:159]
    ds_read_b64_tr_b16 a[44:45], v251 offset:19360
    ds_read_b64_tr_b16 a[46:47], v251 offset:20128
    s_waitcnt lgkmcnt(10)
    v_mfma_f32_32x32x16_bf16 v[64:79], a[24:27], v[60:63], v[64:79]
    ds_read_b64_tr_b16 a[0:1], v251 offset:25600
    ds_read_b64_tr_b16 a[2:3], v251 offset:26368
    s_waitcnt lgkmcnt(10)
    v_mfma_f32_32x32x16_bf16 v[80:95], a[28:31], v[60:63], v[80:95]
    ds_read_b64_tr_b16 a[4:5], v251 offset:25632
    ds_read_b64_tr_b16 a[6:7], v251 offset:26400
    s_waitcnt lgkmcnt(10)
    v_mfma_f32_32x32x16_bf16 v[96:111], a[32:35], v[60:63], v[96:111]
    ds_read_b64_tr_b16 a[8:9], v251 offset:25664
    ds_read_b64_tr_b16 a[10:11], v251 offset:26432
    s_waitcnt lgkmcnt(10)
    v_mfma_f32_32x32x16_bf16 v[112:127], a[36:39], v[60:63], v[112:127]
    ds_read_b64_tr_b16 a[12:13], v251 offset:25696
    ds_read_b64_tr_b16 a[14:15], v251 offset:26464
    s_waitcnt lgkmcnt(10)
    v_mfma_f32_32x32x16_bf16 v[128:143], a[40:43], v[60:63], v[128:143]
    ds_read_b64_tr_b16 a[16:17], v251 offset:25728
    ds_read_b64_tr_b16 a[18:19], v251 offset:26496
    s_waitcnt lgkmcnt(10)
    v_mfma_f32_32x32x16_bf16 v[144:159], a[44:47], v[60:63], v[144:159]
    ds_read_b64_tr_b16 a[20:21], v251 offset:25760
    ds_read_b64_tr_b16 a[22:23], v251 offset:26528
    s_waitcnt vmcnt(22)
    v_max3_u32 v13, v160, v164, v168
    v_max_u32 v13, v13, v172
    v_cmp_eq_u32 vcc, -1, v13
    s_cbranch_vccnz RT_32
BK_33:
    s_waitcnt lgkmcnt(10)
    v_mfma_f32_32x32x16_bf16 v[64:79], a[0:3], v[160:163], v[64:79]
    ds_read_b64_tr_b16 a[24:25], v251 offset:32000
    ds_read_b64_tr_b16 a[26:27], v251 offset:32768
    s_add_u32 s4, s8, 4
    s_and_b32 s4, s4, 7
    s_waitcnt lgkmcnt(10)
    v_mfma_f32_32x32x16_bf16 v[80:95], a[4:7], v[160:163], v[80:95]
    ds_read_b64_tr_b16 a[28:29], v251 offset:32032
    ds_read_b64_tr_b16 a[30:31], v251 offset:32800
    s_waitcnt lgkmcnt(10)
    v_mfma_f32_32x32x16_bf16 v[96:111], a[8:11], v[160:163], v[96:111]
    ds_read_b64_tr_b16 a[32:33], v251 offset:32064
    ds_read_b64_tr_b16 a[34:35], v251 offset:32832
    s_lshl_b32 s4, s4, 12
    s_add_u32 s4, s4, s6
    s_waitcnt lgkmcnt(10)
    v_mfma_f32_32x32x16_bf16 v[112:127], a[12:15], v[160:163], v[112:127]
    ds_read_b64_tr_b16 a[36:37], v251 offset:32096
    ds_read_b64_tr_b16 a[38:39], v251 offset:32864
    s_waitcnt lgkmcnt(10)
    v_mfma_f32_32x32x16_bf16 v[128:143], a[16:19], v[160:163], v[128:143]
    ds_read_b64_tr_b16 a[40:41], v251 offset:32128
    ds_read_b64_tr_b16 a[42:43], v251 offset:32896
    buffer_load_dwordx4 v[48:51], v3, s[24:27], s4 offen offset:0 sc1
    buffer_load_dwordx4 v[52:55], v3, s[24:27], s4 offen offset:1024 sc1
    s_waitcnt lgkmcnt(10)
    v_mfma_f32_32x32x16_bf16 v[144:159], a[20:23], v[160:163], v[144:159]
    ds_read_b64_tr_b16 a[44:45], v251 offset:32160
    ds_read_b64_tr_b16 a[46:47], v251 offset:32928
    s_waitcnt vmcnt(18)
    s_barrier
    s_waitcnt lgkmcnt(10)
    v_mfma_f32_32x32x16_bf16 v[64:79], a[24:27], v[164:167], v[64:79]
    ds_read_b64_tr_b16 a[0:1], v251 offset:38400
    ds_read_b64_tr_b16 a[2:3], v251 offset:39168
    buffer_load_dwordx4 v[56:59], v3, s[24:27], s4 offen offset:2048 sc1
    buffer_load_dwordx4 v[60:63], v3, s[24:27], s4 offen offset:3072 sc1
    s_waitcnt lgkmcnt(10)
    v_mfma_f32_32x32x16_bf16 v[80:95], a[28:31], v[164:167], v[80:95]
    ds_read_b64_tr_b16 a[4:5], v251 offset:38432
    ds_read_b64_tr_b16 a[6:7], v251 offset:39200
    s_lshr_b32 s3, s28, 1
    s_add_u32 s3, s3, 7
    s_waitcnt lgkmcnt(10)
    v_mfma_f32_32x32x16_bf16 v[96:111], a[32:35], v[164:167], v[96:111]
    ds_read_b64_tr_b16 a[8:9], v251 offset:38464
    ds_read_b64_tr_b16 a[10:11], v251 offset:39232
    s_and_b32 s3, s3, 7
    s_mul_i32 s3, s3, 176128
    s_waitcnt lgkmcnt(10)
    v_mfma_f32_32x32x16_bf16 v[112:127], a[36:39], v[164:167], v[112:127]
    ds_read_b64_tr_b16 a[12:13], v251 offset:38496
    ds_read_b64_tr_b16 a[14:15], v251 offset:39264
    s_add_u32 s3, s3, s58
    s_add_u32 m0, s59, 102400
    s_waitcnt lgkmcnt(10)
    v_mfma_f32_32x32x16_bf16 v[128:143], a[40:43], v[164:167], v[128:143]
    ds_read_b64_tr_b16 a[16:17], v251 offset:38528
    ds_read_b64_tr_b16 a[18:19], v251 offset:39296
    buffer_load_dwordx4 v252, s[40:43], s3 offen lds
    s_add_u32 m0, s59, 103424
    s_waitcnt lgkmcnt(10)
    v_mfma_f32_32x32x16_bf16 v[144:159], a[44:47], v[164:167], v[144:159]
    ds_read_b64_tr_b16 a[20:21], v251 offset:38560
    ds_read_b64_tr_b16 a[22:23], v251 offset:39328
    buffer_load_dwordx4 v253, s[40:43], s3 offen lds
    s_add_u32 m0, s59, 104448
    s_waitcnt lgkmcnt(10)
    v_mfma_f32_32x32x16_bf16 v[64:79], a[0:3], v[168:171], v[64:79]
    ds_read_b64_tr_b16 a[24:25], v251 offset:44800
    ds_read_b64_tr_b16 a[26:27], v251 offset:45568
    buffer_load_dwordx4 v254, s[40:43], s3 offen lds
    s_add_u32 m0, s59, 105504
    s_waitcnt lgkmcnt(10)
    v_mfma_f32_32x32x16_bf16 v[80:95], a[4:7], v[168:171], v[80:95]
    ds_read_b64_tr_b16 a[28:29], v251 offset:44832
    ds_read_b64_tr_b16 a[30:31], v251 offset:45600
    buffer_load_dwordx4 v252, s[44:47], s3 offen lds
    s_add_u32 m0, s59, 106528
    s_waitcnt lgkmcnt(10)
    v_mfma_f32_32x32x16_bf16 v[96:111], a[8:11], v[168:171], v[96:111]
    ds_read_b64_tr_b16 a[32:33], v251 offset:44864
    ds_read_b64_tr_b16 a[34:35], v251 offset:45632
    buffer_load_dwordx4 v253, s[44:47], s3 offen lds
    s_add_u32 m0, s59, 107552
    s_waitcnt lgkmcnt(10)
    v_mfma_f32_32x32x16_bf16 v[112:127], a[12:15], v[168:171], v[112:127]
    ds_read_b64_tr_b16 a[36:37], v251 offset:44896
    ds_read_b64_tr_b16 a[38:39], v251 offset:45664
    buffer_load_dwordx4 v254, s[44:47], s3 offen lds
    s_waitcnt lgkmcnt(10)
    v_mfma_f32_32x32x16_bf16 v[128:143], a[16:19], v[168:171], v[128:143]
    ds_read_b64_tr_b16 a[40:41], v251 offset:44928
    ds_read_b64_tr_b16 a[42:43], v251 offset:45696
    s_waitcnt lgkmcnt(10)
    v_mfma_f32_32x32x16_bf16 v[144:159], a[20:23], v[168:171], v[144:159]
    ds_read_b64_tr_b16 a[44:45], v251 offset:44960
    ds_read_b64_tr_b16 a[46:47], v251 offset:45728
    s_waitcnt lgkmcnt(10)
    v_mfma_f32_32x32x16_bf16 v[64:79], a[24:27], v[172:175], v[64:79]
    ds_read_b64_tr_b16 a[0:1], v250 offset:0
    ds_read_b64_tr_b16 a[2:3], v250 offset:768
    s_waitcnt lgkmcnt(10)
    v_mfma_f32_32x32x16_bf16 v[80:95], a[28:31], v[172:175], v[80:95]
    ds_read_b64_tr_b16 a[4:5], v250 offset:32
    ds_read_b64_tr_b16 a[6:7], v250 offset:800
    s_waitcnt lgkmcnt(10)
    v_mfma_f32_32x32x16_bf16 v[96:111], a[32:35], v[172:175], v[96:111]
    ds_read_b64_tr_b16 a[8:9], v250 offset:64
    ds_read_b64_tr_b16 a[10:11], v250 offset:832
    s_waitcnt lgkmcnt(10)
    v_mfma_f32_32x32x16_bf16 v[112:127], a[36:39], v[172:175], v[112:127]
    ds_read_b64_tr_b16 a[12:13], v250 offset:96
    ds_read_b64_tr_b16 a[14:15], v250 offset:864
    s_waitcnt lgkmcnt(10)
    v_mfma_f32_32x32x16_bf16 v[128:143], a[40:43], v[172:175], v[128:143]
    ds_read_b64_tr_b16 a[16:17], v250 offset:128
    ds_read_b64_tr_b16 a[18:19], v250 offset:896
    s_waitcnt lgkmcnt(10)
    v_mfma_f32_32x32x16_bf16 v[144:159], a[44:47], v[172:175], v[144:159]
    ds_read_b64_tr_b16 a[20:21], v250 offset:160
    ds_read_b64_tr_b16 a[22:23], v250 offset:928
    s_waitcnt vmcnt(16)
    v_max3_u32 v13, v32, v36, v40
    v_max_u32 v13, v13, v44
    v_cmp_eq_u32 vcc, -1, v13
    s_cbranch_vccnz RT_34
BK_35:
    s_waitcnt lgkmcnt(10)
    v_mfma_f32_32x32x16_bf16 v[64:79], a[0:3], v[32:35], v[64:79]
    ds_read_b64_tr_b16 a[24:25], v250 offset:6400
    ds_read_b64_tr_b16 a[26:27], v250 offset:7168
    s_add_u32 s4, s8, 5
    s_and_b32 s4, s4, 7
    s_waitcnt lgkmcnt(10)
    v_mfma_f32_32x32x16_bf16 v[80:95], a[4:7], v[32:35], v[80:95]
    ds_read_b64_tr_b16 a[28:29], v250 offset:6432
    ds_read_b64_tr_b16 a[30:31], v250 offset:7200
    s_waitcnt lgkmcnt(10)
    v_mfma_f32_32x32x16_bf16 v[96:111], a[8:11], v[32:35], v[96:111]
    ds_read_b64_tr_b16 a[32:33], v250 offset:6464
    ds_read_b64_tr_b16 a[34:35], v250 offset:7232
    s_lshl_b32 s4, s4, 12
    s_add_u32 s4, s4, s6
    s_waitcnt lgkmcnt(10)
    v_mfma_f32_32x32x16_bf16 v[112:127], a[12:15], v[32:35], v[112:127]
    ds_read_b64_tr_b16 a[36:37], v250 offset:6496
    ds_read_b64_tr_b16 a[38:39], v250 offset:7264
    s_waitcnt lgkmcnt(10)
    v_mfma_f32_32x32x16_bf16 v[128:143], a[16:19], v[32:35], v[128:143]
    ds_read_b64_tr_b16 a[40:41], v250 offset:6528
    ds_read_b64_tr_b16 a[42:43], v250 offset:7296
    buffer_load_dwordx4 v[160:163], v3, s[24:27], s4 offen offset:0 sc1
    buffer_load_dwordx4 v[164:167], v3, s[24:27], s4 offen offset:1024 sc1
    s_waitcnt lgkmcnt(10)
    v_mfma_f32_32x32x16_bf16 v[144:159], a[20:23], v[32:35], v[144:159]
    ds_read_b64_tr_b16 a[44:45], v250 offset:6560
    ds_read_b64_tr_b16 a[46:47], v250 offset:7328
    s_waitcnt lgkmcnt(10)
    v_mfma_f32_32x32x16_bf16 v[64:79], a[24:27], v[36:39], v[64:79]
    ds_read_b64_tr_b16 a[0:1], v250 offset:12800
    ds_read_b64_tr_b16 a[2:3], v250 offset:13568
    buffer_load_dwordx4 v[168:171], v3, s[24:27], s4 offen offset:2048 sc1
    buffer_load_dwordx4 v[172:175], v3, s[24:27], s4 offen offset:3072 sc1
    s_waitcnt lgkmcnt(10)
    v_mfma_f32_32x32x16_bf16 v[80:95], a[28:31], v[36:39], v[80:95]
    ds_read_b64_tr_b16 a[4:5], v250 offset:12832
    ds_read_b64_tr_b16 a[6:7], v250 offset:13600
    s_waitcnt lgkmcnt(10)
    v_mfma_f32_32x32x16_bf16 v[96:111], a[32:35], v[36:39], v[96:111]
    ds_read_b64_tr_b16 a[8:9], v250 offset:12864
    ds_read_b64_tr_b16 a[10:11], v250 offset:13632
    s_waitcnt lgkmcnt(10)
    v_mfma_f32_32x32x16_bf16 v[112:127], a[36:39], v[36:39], v[112:127]
    ds_read_b64_tr_b16 a[12:13], v250 offset:12896
    ds_read_b64_tr_b16 a[14:15], v250 offset:13664
    s_waitcnt lgkmcnt(10)
    v_mfma_f32_32x32x16_bf16 v[128:143], a[40:43], v[36:39], v[128:143]
    ds_read_b64_tr_b16 a[16:17], v250 offset:12928
    ds_read_b64_tr_b16 a[18:19], v250 offset:13696
    s_waitcnt lgkmcnt(10)
    v_mfma_f32_32x32x16_bf16 v[144:159], a[44:47], v[36:39], v[144:159]
    ds_read_b64_tr_b16 a[20:21], v250 offset:12960
    ds_read_b64_tr_b16 a[22:23], v250 offset:13728
    s_waitcnt lgkmcnt(10)
    v_mfma_f32_32x32x16_bf16 v[64:79], a[0:3], v[40:43], v[64:79]
    ds_read_b64_tr_b16 a[24:25], v250 offset:19200
    ds_read_b64_tr_b16 a[26:27], v250 offset:19968
    s_waitcnt lgkmcnt(10)
    v_mfma_f32_32x32x16_bf16 v[80:95], a[4:7], v[40:43], v[80:95]
    ds_read_b64_tr_b16 a[28:29], v250 offset:19232
    ds_read_b64_tr_b16 a[30:31], v250 offset:20000
    s_waitcnt lgkmcnt(10)
    v_mfma_f32_32x32x16_bf16 v[96:111], a[8:11], v[40:43], v[96:111]
    ds_read_b64_tr_b16 a[32:33], v250 offset:19264
    ds_read_b64_tr_b16 a[34:35], v250 offset:20032
    s_waitcnt lgkmcnt(10)
    v_mfma_f32_32x32x16_bf16 v[112:127], a[12:15], v[40:43], v[112:127]
    ds_read_b64_tr_b16 a[36:37], v250 offset:19296
    ds_read_b64_tr_b16 a[38:39], v250 offset:20064
    s_waitcnt lgkmcnt(10)
    v_mfma_f32_32x32x16_bf16 v[128:143], a[16:19], v[40:43], v[128:143]
    ds_read_b64_tr_b16 a[40:41], v250 offset:19328
    ds_read_b64_tr_b16 a[42:43], v250 offset:20096
    s_waitcnt lgkmcnt(10)
    v_mfma_f32_32x32x16_bf16 v[144:159], a[20:23], v[40:43], v[144:159]
    ds_read_b64_tr_b16 a[44:45], v250 offset:19360
    ds_read_b64_tr_b16 a[46:47], v250 offset:20128
    s_waitcnt lgkmcnt(10)
    v_mfma_f32_32x32x16_bf16 v[64:79], a[24:27], v[44:47], v[64:79]
    ds_read_b64_tr_b16 a[0:1], v255 offset:0
    ds_read_b64_tr_b16 a[2:3], v255 offset:768
    s_waitcnt lgkmcnt(10)
    v_mfma_f32_32x32x16_bf16 v[80:95], a[28:31], v[44:47], v[80:95]
    ds_read_b64_tr_b16 a[4:5], v255 offset:32
    ds_read_b64_tr_b16 a[6:7], v255 offset:800
    s_waitcnt lgkmcnt(10)
    v_mfma_f32_32x32x16_bf16 v[96:111], a[32:35], v[44:47], v[96:111]
    ds_read_b64_tr_b16 a[8:9], v255 offset:64
    ds_read_b64_tr_b16 a[10:11], v255 offset:832
    s_waitcnt lgkmcnt(10)
    v_mfma_f32_32x32x16_bf16 v[112:127], a[36:39], v[44:47], v[112:127]
    ds_read_b64_tr_b16 a[12:13], v255 offset:96
    ds_read_b64_tr_b16 a[14:15], v255 offset:864
    s_waitcnt lgkmcnt(10)
    v_mfma_f32_32x32x16_bf16 v[128:143], a[40:43], v[44:47], v[128:143]
    ds_read_b64_tr_b16 a[16:17], v255 offset:128
    ds_read_b64_tr_b16 a[18:19], v255 offset:896
    s_waitcnt lgkmcnt(10)
    v_mfma_f32_32x32x16_bf16 v[144:159], a[44:47], v[44:47], v[144:159]
    ds_read_b64_tr_b16 a[20:21], v255 offset:160
    ds_read_b64_tr_b16 a[22:23], v255 offset:928
    s_waitcnt vmcnt(10)
    v_max3_u32 v13, v48, v52, v56
    v_max_u32 v13, v13, v60
    v_cmp_eq_u32 vcc, -1, v13
    s_cbranch_vccnz RT_36
BK_37:
    s_waitcnt lgkmcnt(10)
    v_mfma_f32_32x32x16_bf16 v[64:79], a[0:3], v[48:51], v[64:79]
    ds_read_b64_tr_b16 a[24:25], v255 offset:6400
    ds_read_b64_tr_b16 a[26:27], v255 offset:7168
    s_add_u32 s4, s8, 6
    s_and_b32 s4, s4, 7
    s_waitcnt lgkmcnt(10)
    v_mfma_f32_32x32x16_bf16 v[80:95], a[4:7], v[48:51], v[80:95]
    ds_read_b64_tr_b16 a[28:29], v255 offset:6432
    ds_read_b64_tr_b16 a[30:31], v255 offset:7200
    s_add_u32 s3, s7, 0
    buffer_load_dwordx4 v[192:195], v10, s[24:27], s3 offen sc1
    s_waitcnt lgkmcnt(10)
    v_mfma_f32_32x32x16_bf16 v[96:111], a[8:11], v[48:51], v[96:111]
    ds_read_b64_tr_b16 a[32:33], v255 offset:6464
    ds_read_b64_tr_b16 a[34:35], v255 offset:7232
    s_lshl_b32 s4, s4, 12
    s_add_u32 s4, s4, s6
    s_waitcnt lgkmcnt(10)
    v_mfma_f32_32x32x16_bf16 v[112:127], a[12:15], v[48:51], v[112:127]
    ds_read_b64_tr_b16 a[36:37], v255 offset:6496
    ds_read_b64_tr_b16 a[38:39], v255 offset:7264
    s_add_u32 s3, s7, 65536
    buffer_load_dwordx4 v[196:199], v10, s[24:27], s3 offen sc1
    s_waitcnt lgkmcnt(10)
    v_mfma_f32_32x32x16_bf16 v[128:143], a[16:19], v[48:51], v[128:143]
    ds_read_b64_tr_b16 a[40:41], v255 offset:6528
    ds_read_b64_tr_b16 a[42:43], v255 offset:7296
    buffer_load_dwordx4 v[32:35], v3, s[24:27], s4 offen offset:0 sc1
    buffer_load_dwordx4 v[36:39], v3, s[24:27], s4 offen offset:1024 sc1
    s_waitcnt lgkmcnt(10)
    v_mfma_f32_32x32x16_bf16 v[144:159], a[20:23], v[48:51], v[144:159]
    ds_read_b64_tr_b16 a[44:45], v255 offset:6560
    ds_read_b64_tr_b16 a[46:47], v255 offset:7328
    s_add_u32 s3, s7, 131072
    buffer_load_dwordx4 v[200:203], v10, s[24:27], s3 offen sc1
    s_barrier
    s_waitcnt lgkmcnt(10)
    v_mfma_f32_32x32x16_bf16 v[64:79], a[24:27], v[52:55], v[64:79]
    ds_read_b64_tr_b16 a[0:1], v255 offset:12800
    ds_read_b64_tr_b16 a[2:3], v255 offset:13568
    buffer_load_dwordx4 v[40:43], v3, s[24:27], s4 offen offset:2048 sc1
    buffer_load_dwordx4 v[44:47], v3, s[24:27], s4 offen offset:3072 sc1
    s_waitcnt lgkmcnt(10)
    v_mfma_f32_32x32x16_bf16 v[80:95], a[28:31], v[52:55], v[80:95]
    ds_read_b64_tr_b16 a[4:5], v255 offset:12832
    ds_read_b64_tr_b16 a[6:7], v255 offset:13600
    s_add_u32 s3, s7, 196608
    buffer_load_dwordx4 v[204:207], v10, s[24:27], s3 offen sc1
    s_waitcnt lgkmcnt(10)
    v_mfma_f32_32x32x16_bf16 v[96:111], a[32:35], v[52:55], v[96:111]
    ds_read_b64_tr_b16 a[8:9], v255 offset:12864
    ds_read_b64_tr_b16 a[10:11], v255 offset:13632
    s_waitcnt lgkmcnt(10)
    v_mfma_f32_32x32x16_bf16 v[112:127], a[36:39], v[52:55], v[112:127]
    ds_read_b64_tr_b16 a[12:13], v255 offset:12896
    ds_read_b64_tr_b16 a[14:15], v255 offset:13664
    s_waitcnt lgkmcnt(10)
    v_mfma_f32_32x32x16_bf16 v[128:143], a[40:43], v[52:55], v[128:143]
    ds_read_b64_tr_b16 a[16:17], v255 offset:12928
    ds_read_b64_tr_b16 a[18:19], v255 offset:13696
    s_waitcnt lgkmcnt(10)
    v_mfma_f32_32x32x16_bf16 v[144:159], a[44:47], v[52:55], v[144:159]
    ds_read_b64_tr_b16 a[20:21], v255 offset:12960
    ds_read_b64_tr_b16 a[22:23], v255 offset:13728
    s_waitcnt lgkmcnt(10)
    v_mfma_f32_32x32x16_bf16 v[64:79], a[0:3], v[56:59], v[64:79]
    ds_read_b64_tr_b16 a[24:25], v255 offset:19200
    ds_read_b64_tr_b16 a[26:27], v255 offset:19968
    s_waitcnt lgkmcnt(10)
    v_mfma_f32_32x32x16_bf16 v[80:95], a[4:7], v[56:59], v[80:95]
    ds_read_b64_tr_b16 a[28:29], v255 offset:19232
    ds_read_b64_tr_b16 a[30:31], v255 offset:20000
    s_waitcnt lgkmcnt(10)
    v_mfma_f32_32x32x16_bf16 v[96:111], a[8:11], v[56:59], v[96:111]
    ds_read_b64_tr_b16 a[32:33], v255 offset:19264
    ds_read_b64_tr_b16 a[34:35], v255 offset:20032
    s_waitcnt lgkmcnt(10)
    v_mfma_f32_32x32x16_bf16 v[112:127], a[12:15], v[56:59], v[112:127]
    ds_read_b64_tr_b16 a[36:37], v255 offset:19296
    ds_read_b64_tr_b16 a[38:39], v255 offset:20064
    s_waitcnt lgkmcnt(10)
    v_mfma_f32_32x32x16_bf16 v[128:143], a[16:19], v[56:59], v[128:143]
    ds_read_b64_tr_b16 a[40:41], v255 offset:19328
    ds_read_b64_tr_b16 a[42:43], v255 offset:20096
    s_waitcnt lgkmcnt(10)
    v_mfma_f32_32x32x16_bf16 v[144:159], a[20:23], v[56:59], v[144:159]
    ds_read_b64_tr_b16 a[44:45], v255 offset:19360
    ds_read_b64_tr_b16 a[46:47], v255 offset:20128
    s_waitcnt lgkmcnt(10)
    v_mfma_f32_32x32x16_bf16 v[64:79], a[24:27], v[60:63], v[64:79]
    ds_read_b64_tr_b16 a[0:1], v255 offset:25600
    ds_read_b64_tr_b16 a[2:3], v255 offset:26368
    s_waitcnt lgkmcnt(10)
    v_mfma_f32_32x32x16_bf16 v[80:95], a[28:31], v[60:63], v[80:95]
    ds_read_b64_tr_b16 a[4:5], v255 offset:25632
    ds_read_b64_tr_b16 a[6:7], v255 offset:26400
    s_waitcnt lgkmcnt(10)
    v_mfma_f32_32x32x16_bf16 v[96:111], a[32:35], v[60:63], v[96:111]
    ds_read_b64_tr_b16 a[8:9], v255 offset:25664
    ds_read_b64_tr_b16 a[10:11], v255 offset:26432
    s_waitcnt lgkmcnt(10)
    v_mfma_f32_32x32x16_bf16 v[112:127], a[36:39], v[60:63], v[112:127]
    ds_read_b64_tr_b16 a[12:13], v255 offset:25696
    ds_read_b64_tr_b16 a[14:15], v255 offset:26464
    s_waitcnt lgkmcnt(10)
    v_mfma_f32_32x32x16_bf16 v[128:143], a[40:43], v[60:63], v[128:143]
    ds_read_b64_tr_b16 a[16:17], v255 offset:25728
    ds_read_b64_tr_b16 a[18:19], v255 offset:26496
    s_waitcnt lgkmcnt(10)
    v_mfma_f32_32x32x16_bf16 v[144:159], a[44:47], v[60:63], v[144:159]
    ds_read_b64_tr_b16 a[20:21], v255 offset:25760
    ds_read_b64_tr_b16 a[22:23], v255 offset:26528
    s_waitcnt vmcnt(8)
    v_max3_u32 v13, v160, v164, v168
    v_max_u32 v13, v13, v172
    v_cmp_eq_u32 vcc, -1, v13
    s_cbranch_vccnz RT_38
BK_39:
    s_waitcnt lgkmcnt(10)
    v_mfma_f32_32x32x16_bf16 v[64:79], a[0:3], v[160:163], v[64:79]
    ds_read_b64_tr_b16 a[24:25], v255 offset:32000
    ds_read_b64_tr_b16 a[26:27], v255 offset:32768
    s_add_u32 s4, s8, 7
    s_and_b32 s4, s4, 7
    s_waitcnt lgkmcnt(10)
    v_mfma_f32_32x32x16_bf16 v[80:95], a[4:7], v[160:163], v[80:95]
    ds_read_b64_tr_b16 a[28:29], v255 offset:32032
    ds_read_b64_tr_b16 a[30:31], v255 offset:32800
    s_waitcnt lgkmcnt(10)
    v_mfma_f32_32x32x16_bf16 v[96:111], a[8:11], v[160:163], v[96:111]
    ds_read_b64_tr_b16 a[32:33], v255 offset:32064
    ds_read_b64_tr_b16 a[34:35], v255 offset:32832
    s_lshl_b32 s4, s4, 12
    s_add_u32 s4, s4, s6
    s_waitcnt lgkmcnt(10)
    v_mfma_f32_32x32x16_bf16 v[112:127], a[12:15], v[160:163], v[112:127]
    ds_read_b64_tr_b16 a[36:37], v255 offset:32096
    ds_read_b64_tr_b16 a[38:39], v255 offset:32864
    s_waitcnt lgkmcnt(10)
    v_mfma_f32_32x32x16_bf16 v[128:143], a[16:19], v[160:163], v[128:143]
    ds_read_b64_tr_b16 a[40:41], v255 offset:32128
    ds_read_b64_tr_b16 a[42:43], v255 offset:32896
    buffer_load_dwordx4 v[48:51], v3, s[24:27], s4 offen offset:0 sc1
    buffer_load_dwordx4 v[52:55], v3, s[24:27], s4 offen offset:1024 sc1
    s_waitcnt lgkmcnt(10)
    v_mfma_f32_32x32x16_bf16 v[144:159], a[20:23], v[160:163], v[144:159]
    ds_read_b64_tr_b16 a[44:45], v255 offset:32160
    ds_read_b64_tr_b16 a[46:47], v255 offset:32928
    s_waitcnt lgkmcnt(10)
    v_mfma_f32_32x32x16_bf16 v[64:79], a[24:27], v[164:167], v[64:79]
    ds_read_b64_tr_b16 a[0:1], v255 offset:38400
    ds_read_b64_tr_b16 a[2:3], v255 offset:39168
    buffer_load_dwordx4 v[56:59], v3, s[24:27], s4 offen offset:2048 sc1
    buffer_load_dwordx4 v[60:63], v3, s[24:27], s4 offen offset:3072 sc1
    s_waitcnt lgkmcnt(10)
    v_mfma_f32_32x32x16_bf16 v[80:95], a[28:31], v[164:167], v[80:95]
    ds_read_b64_tr_b16 a[4:5], v255 offset:38432
    ds_read_b64_tr_b16 a[6:7], v255 offset:39200
    s_waitcnt lgkmcnt(10)
    v_mfma_f32_32x32x16_bf16 v[96:111], a[32:35], v[164:167], v[96:111]
    ds_read_b64_tr_b16 a[8:9], v255 offset:38464
    ds_read_b64_tr_b16 a[10:11], v255 offset:39232
    s_waitcnt lgkmcnt(10)
    v_mfma_f32_32x32x16_bf16 v[112:127], a[36:39], v[164:167], v[112:127]
    ds_read_b64_tr_b16 a[12:13], v255 offset:38496
    ds_read_b64_tr_b16 a[14:15], v255 offset:39264
    s_waitcnt lgkmcnt(10)
    v_mfma_f32_32x32x16_bf16 v[128:143], a[40:43], v[164:167], v[128:143]
    ds_read_b64_tr_b16 a[16:17], v255 offset:38528
    ds_read_b64_tr_b16 a[18:19], v255 offset:39296
    s_waitcnt lgkmcnt(10)
    v_mfma_f32_32x32x16_bf16 v[144:159], a[44:47], v[164:167], v[144:159]
    ds_read_b64_tr_b16 a[20:21], v255 offset:38560
    ds_read_b64_tr_b16 a[22:23], v255 offset:39328
    s_waitcnt lgkmcnt(0)
    s_barrier
    v_mfma_f32_32x32x16_bf16 v[64:79], a[0:3], v[168:171], v[64:79]
    ds_read_b64_tr_b16 a[24:25], v255 offset:44800
    ds_read_b64_tr_b16 a[26:27], v255 offset:45568
    ds_read_b64 a[176:177], v8 offset:0
    ds_read_b64 a[180:181], v8 offset:256
    v_mfma_f32_32x32x16_bf16 v[80:95], a[4:7], v[168:171], v[80:95]
    ds_read_b64_tr_b16 a[28:29], v255 offset:44832
    ds_read_b64_tr_b16 a[30:31], v255 offset:45600
    ds_read_b64 a[184:185], v8 offset:512
    ds_read_b64 a[188:189], v8 offset:768
    v_mfma_f32_32x32x16_bf16 v[96:111], a[8:11], v[168:171], v[96:111]
    ds_read_b64_tr_b16 a[32:33], v255 offset:44864
    ds_read_b64_tr_b16 a[34:35], v255 offset:45632
    ds_read_b64 a[192:193], v8 offset:1024
    ds_read_b64 a[196:197], v8 offset:1280
    v_mfma_f32_32x32x16_bf16 v[112:127], a[12:15], v[168:171], v[112:127]
    ds_read_b64_tr_b16 a[36:37], v255 offset:44896
    ds_read_b64_tr_b16 a[38:39], v255 offset:45664
    s_add_u32 s3, s92, 0
    s_add_u32 m0, s35, 0
    v_mfma_f32_32x32x16_bf16 v[128:143], a[16:19], v[168:171], v[128:143]
    ds_read_b64_tr_b16 a[40:41], v255 offset:44928
    ds_read_b64_tr_b16 a[42:43], v255 offset:45696
    buffer_load_dwordx4 v26, s[48:51], s3 offen lds
    s_add_u32 s3, s92, 8192
    v_mfma_f32_32x32x16_bf16 v[144:159], a[20:23], v[168:171], v[144:159]
    ds_read_b64_tr_b16 a[44:45], v255 offset:44960
    ds_read_b64_tr_b16 a[46:47], v255 offset:45728
    s_add_u32 m0, s35, 1024
    s_nop 0
    buffer_load_dwordx4 v26, s[48:51], s3 offen lds
    s_waitcnt lgkmcnt(15)
    v_mfma_f32_32x32x16_bf16 v[64:79], a[24:27], v[172:175], v[64:79]
    ds_read_b64_tr_b16 a[0:1], v250 offset:25600
    ds_read_b64_tr_b16 a[2:3], v250 offset:26368
    s_add_u32 s3, s92, 16384
    s_add_u32 m0, s35, 2048
    s_waitcnt lgkmcnt(14)
    v_mfma_f32_32x32x16_bf16 v[80:95], a[28:31], v[172:175], v[80:95]
    ds_read_b64_tr_b16 a[4:5], v250 offset:25632
    ds_read_b64_tr_b16 a[6:7], v250 offset:26400
    buffer_load_dwordx4 v26, s[48:51], s3 offen lds
    s_add_u32 s3, s92, 24576
    s_waitcnt lgkmcnt(12)
    v_mfma_f32_32x32x16_bf16 v[96:111], a[32:35], v[172:175], v[96:111]
    ds_read_b64_tr_b16 a[8:9], v250 offset:25664
    ds_read_b64_tr_b16 a[10:11], v250 offset:26432
    s_add_u32 m0, s35, 3072
    s_nop 0
    buffer_load_dwordx4 v26, s[48:51], s3 offen lds
    s_waitcnt lgkmcnt(10)
    v_mfma_f32_32x32x16_bf16 v[112:127], a[36:39], v[172:175], v[112:127]
    ds_read_b64_tr_b16 a[12:13], v250 offset:25696
    ds_read_b64_tr_b16 a[14:15], v250 offset:26464
    s_add_u32 s3, s92, 32768
    s_add_u32 m0, s35, 4096
    s_waitcnt lgkmcnt(10)
    v_mfma_f32_32x32x16_bf16 v[128:143], a[40:43], v[172:175], v[128:143]
    ds_read_b64_tr_b16 a[16:17], v250 offset:25728
    ds_read_b64_tr_b16 a[18:19], v250 offset:26496
    buffer_load_dwordx4 v26, s[48:51], s3 offen lds
    s_add_u32 s3, s92, 40960
    s_waitcnt lgkmcnt(10)
    v_mfma_f32_32x32x16_bf16 v[144:159], a[44:47], v[172:175], v[144:159]
    ds_read_b64_tr_b16 a[20:21], v250 offset:25760
    ds_read_b64_tr_b16 a[22:23], v250 offset:26528
    s_add_u32 m0, s35, 5120
    s_nop 0
    buffer_load_dwordx4 v26, s[48:51], s3 offen lds
    s_waitcnt vmcnt(11)
    v_max3_u32 v13, v32, v36, v40
    v_max_u32 v13, v13, v44
    v_cmp_eq_u32 vcc, -1, v13
    s_cbranch_vccnz RT_40
BK_41:
    s_waitcnt lgkmcnt(10)
    v_mfma_f32_32x32x16_bf16 v[64:79], a[0:3], v[32:35], v[64:79]
    ds_read_b64_tr_b16 a[24:25], v250 offset:32000
    ds_read_b64_tr_b16 a[26:27], v250 offset:32768
    s_waitcnt vmcnt(10)
    v_max3_u32 v208, v192, v193, v194
    v_max3_u32 v208, v208, v195, v196
    v_max3_u32 v208, v208, v197, v198
    v_max3_u32 v208, v208, v199, v200
    v_max3_u32 v208, v208, v201, v202
    v_max3_u32 v208, v208, v203, v204
    v_max3_u32 v208, v208, v205, v206
    v_max_u32 v208, v208, v207
    v_cmp_eq_u32 vcc, -1, v208
    s_cbranch_vccnz RT_42
BK_43:
    s_waitcnt lgkmcnt(10)
    v_mfma_f32_32x32x16_bf16 v[80:95], a[4:7], v[32:35], v[80:95]
    ds_read_b64_tr_b16 a[28:29], v250 offset:32032
    ds_read_b64_tr_b16 a[30:31], v250 offset:32800
    v_add_f32 v192, v192, v196
    v_add_f32 v193, v193, v197
    s_waitcnt lgkmcnt(10)
    v_mfma_f32_32x32x16_bf16 v[96:111], a[8:11], v[32:35], v[96:111]
    ds_read_b64_tr_b16 a[32:33], v250 offset:32064
    ds_read_b64_tr_b16 a[34:35], v250 offset:32832
    v_add_f32 v194, v194, v198
    v_add_f32 v195, v195, v199
    s_waitcnt lgkmcnt(10)
    v_mfma_f32_32x32x16_bf16 v[112:127], a[12:15], v[32:35], v[112:127]
    ds_read_b64_tr_b16 a[36:37], v250 offset:32096
    ds_read_b64_tr_b16 a[38:39], v250 offset:32864
    v_add_f32 v192, v192, v200
    v_add_f32 v193, v193, v201
    s_waitcnt lgkmcnt(10)
    v_mfma_f32_32x32x16_bf16 v[128:143], a[16:19], v[32:35], v[128:143]
    ds_read_b64_tr_b16 a[40:41], v250 offset:32128
    ds_read_b64_tr_b16 a[42:43], v250 offset:32896
    v_add_f32 v194, v194, v202
    v_add_f32 v195, v195, v203
    s_waitcnt lgkmcnt(10)
    v_mfma_f32_32x32x16_bf16 v[144:159], a[20:23], v[32:35], v[144:159]
    ds_read_b64_tr_b16 a[44:45], v250 offset:32160
    ds_read_b64_tr_b16 a[46:47], v250 offset:32928
    v_add_f32 v192, v192, v204
    v_add_f32 v193, v193, v205
    s_waitcnt lgkmcnt(10)
    v_mfma_f32_32x32x16_bf16 v[64:79], a[24:27], v[36:39], v[64:79]
    ds_read_b64_tr_b16 a[0:1], v250 offset:38400
    ds_read_b64_tr_b16 a[2:3], v250 offset:39168
    v_add_f32 v194, v194, v206
    v_add_f32 v195, v195, v207
    s_waitcnt lgkmcnt(10)
    v_mfma_f32_32x32x16_bf16 v[80:95], a[28:31], v[36:39], v[80:95]
    ds_read_b64_tr_b16 a[4:5], v250 offset:38432
    ds_read_b64_tr_b16 a[6:7], v250 offset:39200
    v_permlane32_swap_b32 v192, v194
    v_permlane32_swap_b32 v193, v195
    s_waitcnt lgkmcnt(10)
    v_mfma_f32_32x32x16_bf16 v[96:111], a[32:35], v[36:39], v[96:111]
    ds_read_b64_tr_b16 a[8:9], v250 offset:38464
    ds_read_b64_tr_b16 a[10:11], v250 offset:39232
    v_add_f32 v192, v192, v194
    v_add_f32 v193, v193, v195
    s_waitcnt lgkmcnt(10)
    v_mfma_f32_32x32x16_bf16 v[112:127], a[36:39], v[36:39], v[112:127]
    ds_read_b64_tr_b16 a[12:13], v250 offset:38496
    ds_read_b64_tr_b16 a[14:15], v250 offset:39264
    v_permlane16_swap_b32 v192, v193
    v_add_f32 v192, v192, v193
    s_waitcnt lgkmcnt(10)
    v_mfma_f32_32x32x16_bf16 v[128:143], a[40:43], v[36:39], v[128:143]
    ds_read_b64_tr_b16 a[16:17], v250 offset:38528
    ds_read_b64_tr_b16 a[18:19], v250 offset:39296
    ds_write_b32 v14, v192
    s_add_u32 s3, s92, 49152
    s_waitcnt lgkmcnt(11)
    v_mfma_f32_32x32x16_bf16 v[144:159], a[44:47], v[36:39], v[144:159]
    ds_read_b64_tr_b16 a[20:21], v250 offset:38560
    ds_read_b64_tr_b16 a[22:23], v250 offset:39328
    s_add_u32 m0, s35, 51200
    s_nop 0
    buffer_load_dwordx4 v26, s[48:51], s3 offen lds
    s_waitcnt lgkmcnt(11)
    v_mfma_f32_32x32x16_bf16 v[64:79], a[0:3], v[40:43], v[64:79]
    ds_read_b64_tr_b16 a[24:25], v250 offset:44800
    ds_read_b64_tr_b16 a[26:27], v250 offset:45568
    s_add_u32 s3, s92, 57344
    s_add_u32 m0, s35, 52224
    s_waitcnt lgkmcnt(11)
    v_mfma_f32_32x32x16_bf16 v[80:95], a[4:7], v[40:43], v[80:95]
    ds_read_b64_tr_b16 a[28:29], v250 offset:44832
    ds_read_b64_tr_b16 a[30:31], v250 offset:45600
    buffer_load_dwordx4 v26, s[48:51], s3 offen lds
    s_add_u32 s3, s92, 65536
    s_waitcnt lgkmcnt(11)
    v_mfma_f32_32x32x16_bf16 v[96:111], a[8:11], v[40:43], v[96:111]
    ds_read_b64_tr_b16 a[32:33], v250 offset:44864
    ds_read_b64_tr_b16 a[34:35], v250 offset:45632
    s_add_u32 m0, s35, 53248
    s_nop 0
    buffer_load_dwordx4 v26, s[48:51], s3 offen lds
    s_waitcnt lgkmcnt(11)
    v_mfma_f32_32x32x16_bf16 v[112:127], a[12:15], v[40:43], v[112:127]
    ds_read_b64_tr_b16 a[36:37], v250 offset:44896
    ds_read_b64_tr_b16 a[38:39], v250 offset:45664
    s_add_u32 s3, s92, 73728
    s_add_u32 m0, s35, 54272
    s_waitcnt lgkmcnt(11)
    v_mfma_f32_32x32x16_bf16 v[128:143], a[16:19], v[40:43], v[128:143]
    ds_read_b64_tr_b16 a[40:41], v250 offset:44928
    ds_read_b64_tr_b16 a[42:43], v250 offset:45696
    buffer_load_dwordx4 v26, s[48:51], s3 offen lds
    s_add_u32 s3, s92, 81920
    s_waitcnt lgkmcnt(10)
    v_mfma_f32_32x32x16_bf16 v[144:159], a[20:23], v[40:43], v[144:159]
    ds_read_b64_tr_b16 a[44:45], v250 offset:44960
    ds_read_b64_tr_b16 a[46:47], v250 offset:45728
    s_add_u32 m0, s35, 55296
    s_nop 0
    buffer_load_dwordx4 v26, s[48:51], s3 offen lds
    s_waitcnt lgkmcnt(10)
    v_mfma_f32_32x32x16_bf16 v[64:79], a[24:27], v[44:47], v[64:79]
    ds_read_b64_tr_b16 a[0:1], v251 offset:0
    ds_read_b64_tr_b16 a[2:3], v251 offset:768
    s_add_u32 s3, s92, 90112
    s_add_u32 m0, s35, 56320
    s_waitcnt lgkmcnt(10)
    v_mfma_f32_32x32x16_bf16 v[80:95], a[28:31], v[44:47], v[80:95]
    ds_read_b64_tr_b16 a[4:5], v251 offset:32
    ds_read_b64_tr_b16 a[6:7], v251 offset:800
    buffer_load_dwordx4 v26, s[48:51], s3 offen lds
    s_waitcnt lgkmcnt(10)
    v_mfma_f32_32x32x16_bf16 v[96:111], a[32:35], v[44:47], v[96:111]
    ds_read_b64_tr_b16 a[8:9], v251 offset:64
    ds_read_b64_tr_b16 a[10:11], v251 offset:832
    ds_read_b32 v196, v15
    ds_read_b32 v197, v15 offset:128
    s_waitcnt lgkmcnt(12)
    v_mfma_f32_32x32x16_bf16 v[112:127], a[36:39], v[44:47], v[112:127]
    ds_read_b64_tr_b16 a[12:13], v251 offset:96
    ds_read_b64_tr_b16 a[14:15], v251 offset:864
    s_add_u32 s3, s92, 98304
    s_add_u32 m0, s35, 128000
    s_waitcnt lgkmcnt(12)
    v_mfma_f32_32x32x16_bf16 v[128:143], a[40:43], v[44:47], v[128:143]
    ds_read_b64_tr_b16 a[16:17], v251 offset:128
    ds_read_b64_tr_b16 a[18:19], v251 offset:896
    buffer_load_dwordx4 v26, s[48:51], s3 offen lds
    s_add_u32 s3, s92, 106496
    s_waitcnt lgkmcnt(12)
    v_mfma_f32_32x32x16_bf16 v[144:159], a[44:47], v[44:47], v[144:159]
    ds_read_b64_tr_b16 a[20:21], v251 offset:160
    ds_read_b64_tr_b16 a[22:23], v251 offset:928
    s_add_u32 m0, s35, 129024
    s_nop 0
    buffer_load_dwordx4 v26, s[48:51], s3 offen lds
    s_waitcnt vmcnt(14)
    v_max3_u32 v13, v48, v52, v56
    v_max_u32 v13, v13, v60
    v_cmp_eq_u32 vcc, -1, v13
    s_cbranch_vccnz RT_44
BK_45:
    s_waitcnt lgkmcnt(12)
    v_mfma_f32_32x32x16_bf16 v[64:79], a[0:3], v[48:51], v[64:79]
    ds_read_b64_tr_b16 a[24:25], v251 offset:6400
    ds_read_b64_tr_b16 a[26:27], v251 offset:7168
    s_add_u32 s3, s92, 114688
    s_add_u32 m0, s35, 130048
    s_waitcnt lgkmcnt(12)
    v_mfma_f32_32x32x16_bf16 v[80:95], a[4:7], v[48:51], v[80:95]
    ds_read_b64_tr_b16 a[28:29], v251 offset:6432
    ds_read_b64_tr_b16 a[30:31], v251 offset:7200
    buffer_load_dwordx4 v26, s[48:51], s3 offen lds
    s_add_u32 s3, s92, 122880
    s_waitcnt lgkmcnt(12)
    v_mfma_f32_32x32x16_bf16 v[96:111], a[8:11], v[48:51], v[96:111]
    ds_read_b64_tr_b16 a[32:33], v251 offset:6464
    ds_read_b64_tr_b16 a[34:35], v251 offset:7232
    s_add_u32 m0, s35, 131072
    s_nop 0
    buffer_load_dwordx4 v26, s[48:51], s3 offen lds
    s_waitcnt lgkmcnt(10)
    v_mfma_f32_32x32x16_bf16 v[112:127], a[12:15], v[48:51], v[112:127]
    ds_read_b64_tr_b16 a[36:37], v251 offset:6496
    ds_read_b64_tr_b16 a[38:39], v251 offset:7264
    s_add_u32 s3, s92, 131072
    s_add_u32 m0, s35, 132096
    s_waitcnt lgkmcnt(10)
    v_mfma_f32_32x32x16_bf16 v[128:143], a[16:19], v[48:51], v[128:143]
    ds_read_b64_tr_b16 a[40:41], v251 offset:6528
    ds_read_b64_tr_b16 a[42:43], v251 offset:7296
    buffer_load_dwordx4 v26, s[48:51], s3 offen lds
    s_add_u32 s3, s92, 139264
    s_waitcnt lgkmcnt(10)
    v_mfma_f32_32x32x16_bf16 v[144:159], a[20:23], v[48:51], v[144:159]
    ds_read_b64_tr_b16 a[44:45], v251 offset:6560
    ds_read_b64_tr_b16 a[46:47], v251 offset:7328
    s_add_u32 m0, s35, 133120
    s_nop 0
    buffer_load_dwordx4 v26, s[48:51], s3 offen lds
    s_waitcnt lgkmcnt(10)
    v_mfma_f32_32x32x16_bf16 v[64:79], a[24:27], v[52:55], v[64:79]
    ds_read_b64_tr_b16 a[0:1], v251 offset:12800
    ds_read_b64_tr_b16 a[2:3], v251 offset:13568
    v_mul_f32 v196, 0x3b000000, v196
    s_waitcnt lgkmcnt(10)
    v_mfma_f32_32x32x16_bf16 v[80:95], a[28:31], v[52:55], v[80:95]
    ds_read_b64_tr_b16 a[4:5], v251 offset:12832
    ds_read_b64_tr_b16 a[6:7], v251 offset:13600
    v_mul_f32 v197, 0x3b000000, v197
    v_fma_f32 v197, -v196, v196, v197
    s_waitcnt lgkmcnt(10)
    v_mfma_f32_32x32x16_bf16 v[96:111], a[32:35], v[52:55], v[96:111]
    ds_read_b64_tr_b16 a[8:9], v251 offset:12864
    ds_read_b64_tr_b16 a[10:11], v251 offset:13632
    v_max_f32 v197, 0, v197
    v_cvt_pk_bf16_f32 v198, v197, v197
    s_waitcnt lgkmcnt(10)
    v_mfma_f32_32x32x16_bf16 v[112:127], a[36:39], v[52:55], v[112:127]
    ds_read_b64_tr_b16 a[12:13], v251 offset:12896
    ds_read_b64_tr_b16 a[14:15], v251 offset:13664
    v_lshlrev_b32 v197, 16, v198
    v_add_f32 v197, 0x3727c5ac, v197
    s_waitcnt lgkmcnt(10)
    v_mfma_f32_32x32x16_bf16 v[128:143], a[40:43], v[52:55], v[128:143]
    ds_read_b64_tr_b16 a[16:17], v251 offset:12928
    ds_read_b64_tr_b16 a[18:19], v251 offset:13696
    v_cvt_pk_bf16_f32 v198, v197, v197
    v_lshlrev_b32 v197, 16, v198
    s_waitcnt lgkmcnt(10)
    v_mfma_f32_32x32x16_bf16 v[144:159], a[44:47], v[52:55], v[144:159]
    ds_read_b64_tr_b16 a[20:21], v251 offset:12960
    ds_read_b64_tr_b16 a[22:23], v251 offset:13728
    v_sqrt_f32 v197, v197
    v_cvt_pk_bf16_f32 v20, -v196, -v196
    s_waitcnt lgkmcnt(10)
    v_mfma_f32_32x32x16_bf16 v[64:79], a[0:3], v[56:59], v[64:79]
    ds_read_b64_tr_b16 a[24:25], v251 offset:19200
    ds_read_b64_tr_b16 a[26:27], v251 offset:19968
    v_cvt_pk_bf16_f32 v21, v197, v197
    v_lshlrev_b32 v197, 16, v21
    s_waitcnt lgkmcnt(10)
    v_mfma_f32_32x32x16_bf16 v[80:95], a[4:7], v[56:59], v[80:95]
    ds_read_b64_tr_b16 a[28:29], v251 offset:19232
    ds_read_b64_tr_b16 a[30:31], v251 offset:20000
    v_rcp_f32 v24, v197
    v_cmp_gt_u32 vcc, 32, v1
    v_mov_b32 v22, 0
    v_mov_b32 v23, 0
    v_cndmask_b32 v20, 0, v20, vcc
    v_cndmask_b32 v21, 0, v21, vcc
    s_waitcnt lgkmcnt(10)
    v_mfma_f32_32x32x16_bf16 v[96:111], a[8:11], v[56:59], v[96:111]
    ds_read_b64_tr_b16 a[32:33], v251 offset:19264
    ds_read_b64_tr_b16 a[34:35], v251 offset:20032
    v_mul_f32 v24, v24, v24
    s_mul_i32 s7, s11, 86
    s_waitcnt lgkmcnt(10)
    v_mfma_f32_32x32x16_bf16 v[112:127], a[12:15], v[56:59], v[112:127]
    ds_read_b64_tr_b16 a[36:37], v251 offset:19296
    ds_read_b64_tr_b16 a[38:39], v251 offset:20064
    s_add_u32 s7, s7, s10
    s_lshl_b32 s7, s7, 10
    s_waitcnt lgkmcnt(10)
    v_mfma_f32_32x32x16_bf16 v[128:143], a[16:19], v[56:59], v[128:143]
    ds_read_b64_tr_b16 a[40:41], v251 offset:19328
    ds_read_b64_tr_b16 a[42:43], v251 offset:20096
    s_add_u32 s7, s7, 13631488
    s_add_u32 s9, s7, 4096
    s_waitcnt lgkmcnt(10)
    v_mfma_f32_32x32x16_bf16 v[144:159], a[20:23], v[56:59], v[144:159]
    ds_read_b64_tr_b16 a[44:45], v251 offset:19360
    ds_read_b64_tr_b16 a[46:47], v251 offset:20128
    s_and_b32 s56, s10, 15
    s_cmp_eq_u32 s56, 12
    s_cselect_b32 s56, 0x7f000000, s9
    s_waitcnt lgkmcnt(10)
    v_mfma_f32_32x32x16_bf16 v[64:79], a[24:27], v[60:63], v[64:79]
    v_mfma_f32_32x32x16_bf16 v[64:79], a[176:179], v[20:23], v[64:79]
    s_waitcnt lgkmcnt(8)
    v_mfma_f32_32x32x16_bf16 v[80:95], a[28:31], v[60:63], v[80:95]
    v_mfma_f32_32x32x16_bf16 v[80:95], a[180:183], v[20:23], v[80:95]
    s_nop 8
    v_mul_f32 v64, v64, v72
    v_mul_f32 v65, v65, v73
    v_mul_f32 v66, v66, v74
    v_mul_f32 v67, v67, v75
    v_mul_f32 v68, v68, v76
    v_mul_f32 v69, v69, v77
    v_mul_f32 v70, v70, v78
    v_mul_f32 v71, v71, v79
    v_mul_f32 v64, v64, v24
    v_mul_f32 v65, v65, v24
    v_mul_f32 v66, v66, v24
    v_mul_f32 v67, v67, v24
    v_mul_f32 v68, v68, v24
    v_mul_f32 v69, v69, v24
    v_mul_f32 v70, v70, v24
    v_mul_f32 v71, v71, v24
    v_cvt_pk_bf16_f32 v72, v64, v65
    v_cvt_pk_bf16_f32 v73, v66, v67
    v_cvt_pk_bf16_f32 v74, v68, v69
    v_cvt_pk_bf16_f32 v75, v70, v71
    buffer_store_dwordx4 v[72:75], v3, s[24:27], s7 offen offset:0 sc1
    s_waitcnt lgkmcnt(6)
    v_mfma_f32_32x32x16_bf16 v[96:111], a[32:35], v[60:63], v[96:111]
    v_mfma_f32_32x32x16_bf16 v[96:111], a[184:187], v[20:23], v[96:111]
    v_mul_f32 v80, v80, v88
    v_mul_f32 v81, v81, v89
    v_mul_f32 v82, v82, v90
    v_mul_f32 v83, v83, v91
    v_mul_f32 v84, v84, v92
    v_mul_f32 v85, v85, v93
    v_mul_f32 v86, v86, v94
    v_mul_f32 v87, v87, v95
    v_mul_f32 v80, v80, v24
    v_mul_f32 v81, v81, v24
    v_mul_f32 v82, v82, v24
    v_mul_f32 v83, v83, v24
    v_mul_f32 v84, v84, v24
    v_mul_f32 v85, v85, v24
    v_mul_f32 v86, v86, v24
    v_mul_f32 v87, v87, v24
    v_cvt_pk_bf16_f32 v88, v80, v81
    v_cvt_pk_bf16_f32 v89, v82, v83
    v_cvt_pk_bf16_f32 v90, v84, v85
    v_cvt_pk_bf16_f32 v91, v86, v87
    buffer_store_dwordx4 v[88:91], v3, s[24:27], s7 offen offset:1024 sc1
    s_waitcnt lgkmcnt(4)
    v_mfma_f32_32x32x16_bf16 v[112:127], a[36:39], v[60:63], v[112:127]
    v_mfma_f32_32x32x16_bf16 v[112:127], a[188:191], v[20:23], v[112:127]
    v_mul_f32 v96, v96, v104
    v_mul_f32 v97, v97, v105
    v_mul_f32 v98, v98, v106
    v_mul_f32 v99, v99, v107
    v_mul_f32 v100, v100, v108
    v_mul_f32 v101, v101, v109
    v_mul_f32 v102, v102, v110
    v_mul_f32 v103, v103, v111
    v_mul_f32 v96, v96, v24
    v_mul_f32 v97, v97, v24
    v_mul_f32 v98, v98, v24
    v_mul_f32 v99, v99, v24
    v_mul_f32 v100, v100, v24
    v_mul_f32 v101, v101, v24
    v_mul_f32 v102, v102, v24
    v_mul_f32 v103, v103, v24
    v_cvt_pk_bf16_f32 v104, v96, v97
    v_cvt_pk_bf16_f32 v105, v98, v99
    v_cvt_pk_bf16_f32 v106, v100, v101
    v_cvt_pk_bf16_f32 v107, v102, v103
    buffer_store_dwordx4 v[104:107], v3, s[24:27], s7 offen offset:2048 sc1
    s_waitcnt lgkmcnt(2)
    v_mfma_f32_32x32x16_bf16 v[128:143], a[40:43], v[60:63], v[128:143]
    v_mfma_f32_32x32x16_bf16 v[128:143], a[192:195], v[20:23], v[128:143]
    v_mul_f32 v112, v112, v120
    v_mul_f32 v113, v113, v121
    v_mul_f32 v114, v114, v122
    v_mul_f32 v115, v115, v123
    v_mul_f32 v116, v116, v124
    v_mul_f32 v117, v117, v125
    v_mul_f32 v118, v118, v126
    v_mul_f32 v119, v119, v127
    v_mul_f32 v112, v112, v24
    v_mul_f32 v113, v113, v24
    v_mul_f32 v114, v114, v24
    v_mul_f32 v115, v115, v24
    v_mul_f32 v116, v116, v24
    v_mul_f32 v117, v117, v24
    v_mul_f32 v118, v118, v24
    v_mul_f32 v119, v119, v24
    v_cvt_pk_bf16_f32 v120, v112, v113
    v_cvt_pk_bf16_f32 v121, v114, v115
    v_cvt_pk_bf16_f32 v122, v116, v117
    v_cvt_pk_bf16_f32 v123, v118, v119
    buffer_store_dwordx4 v[120:123], v3, s[24:27], s7 offen offset:3072 sc1
    s_waitcnt lgkmcnt(0)
    v_mfma_f32_32x32x16_bf16 v[144:159], a[44:47], v[60:63], v[144:159]
    v_mfma_f32_32x32x16_bf16 v[144:159], a[196:199], v[20:23], v[144:159]
    v_mul_f32 v128, v128, v136
    v_mul_f32 v129, v129, v137
    v_mul_f32 v130, v130, v138
    v_mul_f32 v131, v131, v139
    v_mul_f32 v132, v132, v140
    v_mul_f32 v133, v133, v141
    v_mul_f32 v134, v134, v142
    v_mul_f32 v135, v135, v143
    v_mul_f32 v128, v128, v24
    v_mul_f32 v129, v129, v24
    v_mul_f32 v130, v130, v24
    v_mul_f32 v131, v131, v24
    v_mul_f32 v132, v132, v24
    v_mul_f32 v133, v133, v24
    v_mul_f32 v134, v134, v24
    v_mul_f32 v135, v135, v24
    v_cvt_pk_bf16_f32 v136, v128, v129
    v_cvt_pk_bf16_f32 v137, v130, v131
    v_cvt_pk_bf16_f32 v138, v132, v133
    v_cvt_pk_bf16_f32 v139, v134, v135
    buffer_store_dwordx4 v[136:139], v3, s[24:27], s56 offen offset:0 sc1
    v_mul_f32 v144, v144, v152
    v_mul_f32 v145, v145, v153
    v_mul_f32 v146, v146, v154
    v_mul_f32 v147, v147, v155
    v_mul_f32 v148, v148, v156
    v_mul_f32 v149, v149, v157
    v_mul_f32 v150, v150, v158
    v_mul_f32 v151, v151, v159
    v_mul_f32 v144, v144, v24
    v_mul_f32 v145, v145, v24
    v_mul_f32 v146, v146, v24
    v_mul_f32 v147, v147, v24
    v_mul_f32 v148, v148, v24
    v_mul_f32 v149, v149, v24
    v_mul_f32 v150, v150, v24
    v_mul_f32 v151, v151, v24
    v_cvt_pk_bf16_f32 v152, v144, v145
    v_cvt_pk_bf16_f32 v153, v146, v147
    v_cvt_pk_bf16_f32 v154, v148, v149
    v_cvt_pk_bf16_f32 v155, v150, v151
    buffer_store_dwordx4 v[152:155], v3, s[24:27], s56 offen offset:1024 sc1
    s_barrier
    s_lshl_b32 s9, s31, 11
    s_add_u32 s9, s9, 81920
    v_lshlrev_b32 v25, 5, v1
    buffer_load_dwordx4 v[192:195], v25, s[24:27], s9 offen offset:0 sc1
    buffer_load_dwordx4 v[196:199], v25, s[24:27], s9 offen offset:16 sc1
    s_mul_i32 s4, s30, 12288
    s_lshl_b32 s5, s30, 11
    s_add_u32 s3, s92, 147456
    s_add_u32 m0, s35, 25600
    s_nop 0
    buffer_load_dwordx4 v26, s[48:51], s3 offen lds
    s_add_u32 s3, s92, 155648
    s_add_u32 m0, s35, 26624
    s_nop 0
    buffer_load_dwordx4 v26, s[48:51], s3 offen lds
    s_add_u32 s3, s92, 163840
    s_add_u32 m0, s35, 27648
    s_nop 0
    buffer_load_dwordx4 v26, s[48:51], s3 offen lds
    s_add_u32 s3, s92, 172032
    s_add_u32 m0, s35, 28672
    s_nop 0
    buffer_load_dwordx4 v26, s[48:51], s3 offen lds
    s_add_u32 s3, s92, 180224
    s_add_u32 m0, s35, 29696
    s_nop 0
    buffer_load_dwordx4 v26, s[48:51], s3 offen lds
    s_add_u32 s3, s92, 188416
    s_add_u32 m0, s35, 30720
    s_nop 0
    buffer_load_dwordx4 v26, s[48:51], s3 offen lds
    s_add_u32 s3, s92, 196608
    s_add_u32 m0, s4, 76800
    s_nop 0
    buffer_load_dwordx4 v26, s[48:51], s3 offen lds
    s_add_u32 s3, s92, 204800
    s_add_u32 m0, s4, 77824
    s_nop 0
    buffer_load_dwordx4 v26, s[48:51], s3 offen lds
    s_add_u32 s3, s92, 212992
    s_add_u32 m0, s4, 78848
    s_nop 0
    buffer_load_dwordx4 v26, s[48:51], s3 offen lds
    s_add_u32 s3, s92, 221184
    s_add_u32 m0, s4, 79872
    s_nop 0
    buffer_load_dwordx4 v26, s[48:51], s3 offen lds
    s_add_u32 s3, s92, 229376
    s_add_u32 m0, s4, 80896
    s_nop 0
    buffer_load_dwordx4 v26, s[48:51], s3 offen lds
    s_add_u32 s3, s92, 237568
    s_add_u32 m0, s4, 81920
    s_nop 0
    buffer_load_dwordx4 v26, s[48:51], s3 offen lds
    s_add_u32 s3, s92, 245760
    s_add_u32 m0, s4, 82944
    s_nop 0
    buffer_load_dwordx4 v26, s[48:51], s3 offen lds
    s_add_u32 s3, s92, 253952
    s_add_u32 m0, s4, 83968
    s_nop 0
    buffer_load_dwordx4 v26, s[48:51], s3 offen lds
    s_add_u32 s3, s92, 262144
    s_add_u32 m0, s4, 84992
    s_nop 0
    buffer_load_dwordx4 v26, s[48:51], s3 offen lds
    s_add_u32 s3, s92, 270336
    s_add_u32 m0, s4, 86016
    s_nop 0
    buffer_load_dwordx4 v26, s[48:51], s3 offen lds
    s_add_u32 s3, s92, 278528
    s_add_u32 m0, s4, 87040
    s_nop 0
    buffer_load_dwordx4 v26, s[48:51], s3 offen lds
    s_add_u32 s3, s92, 286720
    s_add_u32 m0, s4, 88064
    s_nop 0
    buffer_load_dwordx4 v26, s[48:51], s3 offen lds
    s_add_u32 s3, s92, 294912
    s_add_u32 m0, s5, 153600
    s_nop 0
    buffer_load_dwordx4 v26, s[48:51], s3 offen lds
    s_add_u32 s3, s92, 303104
    s_add_u32 m0, s5, 154624
    s_nop 0
    buffer_load_dwordx4 v26, s[48:51], s3 offen lds
    v_bfe_u32 v13, v1, 4, 1
    v_and_b32 v8, 1, v1
    v_lshlrev_b32 v8, 4, v8
    v_lshl_add_u32 v8, v13, 5, v8
    v_bfe_u32 v13, v1, 1, 1
    v_lshl_add_u32 v8, v13, 3, v8
    v_bfe_u32 v13, v1, 4, 1
    v_bfe_u32 v13, v1, 2, 2
    v_lshrrev_b32 v9, 1, v13
    v_xor_b32 v9, v9, v13
    v_xor_b32 v9, s34, v9
    v_and_b32 v9, 1, v9
    v_lshl_add_u32 v8, v9, 6, v8
    v_lshl_add_u32 v8, v13, 7, v8
    v_lshrrev_b32 v13, 5, v1
    v_lshl_add_u32 v8, v13, 10, v8
    v_add_u32 v8, s35, v8
    v_xor_b32 v9, 64, v8
    s_mul_i32 s3, s30, 6144
    s_mul_i32 s6, s30, 0
    s_add_u32 s6, s6, 128000
    v_add_u32 v10, s6, v8
    v_add_u32 v11, s6, v9
    s_mul_i32 s6, s30, 6144
    s_add_u32 s6, s6, 76800
    v_add_u32 v14, s6, v8
    v_add_u32 v15, s6, v9
    s_mul_i32 s6, s30, 4294963200
    s_add_u32 s6, s6, 153600
    v_add_u32 v20, s6, v8
    v_add_u32 v21, s6, v9
    s_mul_i32 s6, s60, 86
    s_add_u32 s6, s6, s64
    s_lshl_b32 s6, s6, 10
    s_add_u32 s6, s6, 13631488
    s_mul_i32 s7, s61, 86
    s_add_u32 s7, s7, s64
    s_lshl_b32 s7, s7, 10
    s_add_u32 s7, s7, 13631488
    s_cmp_ge_u32 s30, 2
    s_cselect_b32 s8, 0x7f000000, 0
    s_waitcnt vmcnt(20)
PGC_47:
    v_xor_b32 v13, v193, v12
    v_bitop3_b32 v13, v13, v195, v12 bitop3:0xf6
    v_bitop3_b32 v13, v13, v197, v12 bitop3:0xf6
    v_bitop3_b32 v13, v13, v199, v12 bitop3:0xf6
    v_cmp_ne_u32 vcc, 0, v13
    s_cbranch_vccnz PG_46
PGD_48:
    v_add_f32 v192, v192, v194
    v_add_f32 v196, v196, v198
    v_add_f32 v192, v192, v196
    v_cvt_pk_bf16_f32 v193, v192, v192
    v_lshlrev_b32 v192, 16, v193
    v_lshlrev_b32 v13, 2, v0
    v_add_u32 v13, 161792, v13
    ds_write_b32 v13, v192
    s_lshl_b32 s3, s30, 8
    s_lshl_b32 s9, s34, 7
    s_add_u32 s3, s3, s9
    s_add_u32 s3, s3, 161792
    v_lshlrev_b32 v13, 5, v6
    v_add_u32 v13, s3, v13
    s_waitcnt lgkmcnt(0)
    ds_read_b128 v[224:227], v13 offset:0
    ds_read_b128 v[228:231], v13 offset:16
    ds_read_b128 v[232:235], v13 offset:64
    ds_read_b128 v[236:239], v13 offset:80
    s_waitcnt lgkmcnt(0)
    s_add_u32 s3, s6, 0
    buffer_load_dwordx4 v[96:99], v3, s[24:27], s3 offen offset:0 sc1
    buffer_load_dwordx4 v[104:107], v3, s[24:27], s3 offen offset:1024 sc1
    s_add_u32 s3, s7, 0
    buffer_load_dwordx4 v[100:103], v3, s[24:27], s3 offen offset:0 sc1
    buffer_load_dwordx4 v[108:111], v3, s[24:27], s3 offen offset:1024 sc1
    s_add_u32 s3, s6, 2048
    buffer_load_dwordx4 v[112:115], v3, s[24:27], s3 offen offset:0 sc1
    buffer_load_dwordx4 v[120:123], v3, s[24:27], s3 offen offset:1024 sc1
    s_add_u32 s3, s7, 2048
    buffer_load_dwordx4 v[116:119], v3, s[24:27], s3 offen offset:0 sc1
    buffer_load_dwordx4 v[124:127], v3, s[24:27], s3 offen offset:1024 sc1
    s_add_u32 s3, s6, 4096
    buffer_load_dwordx4 v[128:131], v3, s[24:27], s3 offen offset:0 sc1
    buffer_load_dwordx4 v[136:139], v3, s[24:27], s3 offen offset:1024 sc1
    s_add_u32 s3, s7, 4096
    buffer_load_dwordx4 v[132:135], v3, s[24:27], s3 offen offset:0 sc1
    buffer_load_dwordx4 v[140:143], v3, s[24:27], s3 offen offset:1024 sc1
    s_waitcnt vmcnt(8)
    ds_read_b64_tr_b16 a[0:1], v8 offset:0
    ds_read_b64_tr_b16 a[2:3], v8 offset:512
    ds_read_b64_tr_b16 a[4:5], v9 offset:0
    ds_read_b64_tr_b16 a[6:7], v9 offset:512
    ds_read_b64_tr_b16 a[8:9], v8 offset:2048
    ds_read_b64_tr_b16 a[10:11], v8 offset:2560
    ds_read_b64_tr_b16 a[12:13], v9 offset:2048
    ds_read_b64_tr_b16 a[14:15], v9 offset:2560
    v_max3_u32 v13, v96, v100, v104
    v_max_u32 v13, v13, v108
    v_cmp_eq_u32 vcc, -1, v13
    s_cbranch_vccnz RT_49
BK_50:
    s_add_u32 s3, s6, 6144
    buffer_load_dwordx4 v[144:147], v3, s[24:27], s3 offen offset:0 sc1
    buffer_load_dwordx4 v[152:155], v3, s[24:27], s3 offen offset:1024 sc1
    s_add_u32 s3, s7, 6144
    buffer_load_dwordx4 v[148:151], v3, s[24:27], s3 offen offset:0 sc1
    buffer_load_dwordx4 v[156:159], v3, s[24:27], s3 offen offset:1024 sc1
    ds_read_b64_tr_b16 a[16:17], v8 offset:4096
    ds_read_b64_tr_b16 a[18:19], v8 offset:4608
    ds_read_b64_tr_b16 a[20:21], v9 offset:4096
    ds_read_b64_tr_b16 a[22:23], v9 offset:4608
    s_waitcnt lgkmcnt(8)
    v_mfma_f32_32x32x16_bf16 v[80:95], a[4:7], v[100:103], 0
    v_mfma_f32_32x32x16_bf16 v[64:79], a[4:7], v[96:99], 0
    v_mfma_f32_32x32x16_bf16 v[48:63], a[0:3], v[100:103], 0
    v_mfma_f32_32x32x16_bf16 v[32:47], a[0:3], v[96:99], 0
    ds_read_b64_tr_b16 a[0:1], v8 offset:51200
    ds_read_b64_tr_b16 a[2:3], v8 offset:51712
    ds_read_b64_tr_b16 a[4:5], v9 offset:51200
    ds_read_b64_tr_b16 a[6:7], v9 offset:51712
    s_waitcnt lgkmcnt(8)
    v_mfma_f32_32x32x16_bf16 v[80:95], a[12:15], v[108:111], v[80:95]
    v_mfma_f32_32x32x16_bf16 v[64:79], a[12:15], v[104:107], v[64:79]
    v_mfma_f32_32x32x16_bf16 v[48:63], a[8:11], v[108:111], v[48:63]
    v_mfma_f32_32x32x16_bf16 v[32:47], a[8:11], v[104:107], v[32:47]
    s_waitcnt vmcnt(8)
    v_max3_u32 v13, v112, v116, v120
    v_max_u32 v13, v13, v124
    v_cmp_eq_u32 vcc, -1, v13
    s_cbranch_vccnz RT_51
BK_52:
    s_add_u32 s3, s6, 8192
    buffer_load_dwordx4 v[96:99], v3, s[24:27], s3 offen offset:0 sc1
    buffer_load_dwordx4 v[104:107], v3, s[24:27], s3 offen offset:1024 sc1
    s_add_u32 s3, s7, 8192
    buffer_load_dwordx4 v[100:103], v3, s[24:27], s3 offen offset:0 sc1
    buffer_load_dwordx4 v[108:111], v3, s[24:27], s3 offen offset:1024 sc1
    ds_read_b64_tr_b16 a[8:9], v8 offset:53248
    ds_read_b64_tr_b16 a[10:11], v8 offset:53760
    ds_read_b64_tr_b16 a[12:13], v9 offset:53248
    ds_read_b64_tr_b16 a[14:15], v9 offset:53760
    s_waitcnt lgkmcnt(8)
    v_mfma_f32_32x32x16_bf16 v[80:95], a[20:23], v[116:119], v[80:95]
    v_mfma_f32_32x32x16_bf16 v[64:79], a[20:23], v[112:115], v[64:79]
    v_mfma_f32_32x32x16_bf16 v[48:63], a[16:19], v[116:119], v[48:63]
    v_mfma_f32_32x32x16_bf16 v[32:47], a[16:19], v[112:115], v[32:47]
    ds_read_b64_tr_b16 a[16:17], v8 offset:55296
    ds_read_b64_tr_b16 a[18:19], v8 offset:55808
    ds_read_b64_tr_b16 a[20:21], v9 offset:55296
    ds_read_b64_tr_b16 a[22:23], v9 offset:55808
    s_waitcnt lgkmcnt(8)
    v_mfma_f32_32x32x16_bf16 v[80:95], a[4:7], v[124:127], v[80:95]
    v_mfma_f32_32x32x16_bf16 v[64:79], a[4:7], v[120:123], v[64:79]
    v_mfma_f32_32x32x16_bf16 v[48:63], a[0:3], v[124:127], v[48:63]
    v_mfma_f32_32x32x16_bf16 v[32:47], a[0:3], v[120:123], v[32:47]
    s_waitcnt vmcnt(8)
    v_max3_u32 v13, v128, v132, v136
    v_max_u32 v13, v13, v140
    v_cmp_eq_u32 vcc, -1, v13
    s_cbranch_vccnz RT_53
BK_54:
    s_add_u32 s3, s6, 10240
    buffer_load_dwordx4 v[112:115], v3, s[24:27], s3 offen offset:0 sc1
    buffer_load_dwordx4 v[120:123], v3, s[24:27], s3 offen offset:1024 sc1
    s_add_u32 s3, s7, 10240
    buffer_load_dwordx4 v[116:119], v3, s[24:27], s3 offen offset:0 sc1
    buffer_load_dwordx4 v[124:127], v3, s[24:27], s3 offen offset:1024 sc1
    s_add_u32 s3, s92, 311296
    s_add_u32 m0, s35, 0
    s_nop 0
    buffer_load_dwordx4 v26, s[48:51], s3 offen lds
    s_add_u32 s3, s92, 319488
    s_add_u32 m0, s35, 1024
    s_nop 0
    buffer_load_dwordx4 v26, s[48:51], s3 offen lds
    ds_read_b64_tr_b16 a[0:1], v10 offset:0
    ds_read_b64_tr_b16 a[2:3], v10 offset:512
    ds_read_b64_tr_b16 a[4:5], v11 offset:0
    ds_read_b64_tr_b16 a[6:7], v11 offset:512
    s_waitcnt lgkmcnt(8)
    v_mfma_f32_32x32x16_bf16 v[80:95], a[12:15], v[132:135], v[80:95]
    v_mfma_f32_32x32x16_bf16 v[64:79], a[12:15], v[128:131], v[64:79]
    v_mfma_f32_32x32x16_bf16 v[48:63], a[8:11], v[132:135], v[48:63]
    v_mfma_f32_32x32x16_bf16 v[32:47], a[8:11], v[128:131], v[32:47]
    ds_read_b64_tr_b16 a[8:9], v10 offset:2048
    ds_read_b64_tr_b16 a[10:11], v10 offset:2560
    ds_read_b64_tr_b16 a[12:13], v11 offset:2048
    ds_read_b64_tr_b16 a[14:15], v11 offset:2560
    s_waitcnt lgkmcnt(8)
    v_mfma_f32_32x32x16_bf16 v[80:95], a[20:23], v[140:143], v[80:95]
    v_mfma_f32_32x32x16_bf16 v[64:79], a[20:23], v[136:139], v[64:79]
    v_mfma_f32_32x32x16_bf16 v[48:63], a[16:19], v[140:143], v[48:63]
    v_mfma_f32_32x32x16_bf16 v[32:47], a[16:19], v[136:139], v[32:47]
    s_waitcnt vmcnt(10)
    v_max3_u32 v13, v144, v148, v152
    v_max_u32 v13, v13, v156
    v_cmp_eq_u32 vcc, -1, v13
    s_cbranch_vccnz RT_55
BK_56:
    s_add_u32 s3, s6, 12288
    buffer_load_dwordx4 v[128:131], v3, s[24:27], s3 offen offset:0 sc1
    buffer_load_dwordx4 v[136:139], v3, s[24:27], s3 offen offset:1024 sc1
    s_add_u32 s3, s7, 12288
    buffer_load_dwordx4 v[132:135], v3, s[24:27], s3 offen offset:0 sc1
    buffer_load_dwordx4 v[140:143], v3, s[24:27], s3 offen offset:1024 sc1
    s_add_u32 s3, s92, 327680
    s_add_u32 m0, s35, 2048
    s_nop 0
    buffer_load_dwordx4 v26, s[48:51], s3 offen lds
    s_add_u32 s3, s92, 335872
    s_add_u32 m0, s35, 3072
    s_nop 0
    buffer_load_dwordx4 v26, s[48:51], s3 offen lds
    ds_read_b64_tr_b16 a[16:17], v10 offset:4096
    ds_read_b64_tr_b16 a[18:19], v10 offset:4608
    ds_read_b64_tr_b16 a[20:21], v11 offset:4096
    ds_read_b64_tr_b16 a[22:23], v11 offset:4608
    s_waitcnt lgkmcnt(8)
    v_mfma_f32_32x32x16_bf16 v[80:95], a[4:7], v[148:151], v[80:95]
    v_mfma_f32_32x32x16_bf16 v[64:79], a[4:7], v[144:147], v[64:79]
    v_mfma_f32_32x32x16_bf16 v[48:63], a[0:3], v[148:151], v[48:63]
    v_mfma_f32_32x32x16_bf16 v[32:47], a[0:3], v[144:147], v[32:47]
    ds_read_b64_tr_b16 a[0:1], v8 offset:25600
    ds_read_b64_tr_b16 a[2:3], v8 offset:26112
    ds_read_b64_tr_b16 a[4:5], v9 offset:25600
    ds_read_b64_tr_b16 a[6:7], v9 offset:26112
    s_waitcnt lgkmcnt(8)
    v_mfma_f32_32x32x16_bf16 v[80:95], a[12:15], v[156:159], v[80:95]
    v_mfma_f32_32x32x16_bf16 v[64:79], a[12:15], v[152:155], v[64:79]
    v_mfma_f32_32x32x16_bf16 v[48:63], a[8:11], v[156:159], v[48:63]
    v_mfma_f32_32x32x16_bf16 v[32:47], a[8:11], v[152:155], v[32:47]
    s_waitcnt vmcnt(12)
    v_max3_u32 v13, v96, v100, v104
    v_max_u32 v13, v13, v108
    v_cmp_eq_u32 vcc, -1, v13
    s_cbranch_vccnz RT_57
BK_58:
    s_add_u32 s3, s6, 14336
    buffer_load_dwordx4 v[144:147], v3, s[24:27], s3 offen offset:0 sc1
    buffer_load_dwordx4 v[152:155], v3, s[24:27], s3 offen offset:1024 sc1
    s_add_u32 s3, s7, 14336
    buffer_load_dwordx4 v[148:151], v3, s[24:27], s3 offen offset:0 sc1
    buffer_load_dwordx4 v[156:159], v3, s[24:27], s3 offen offset:1024 sc1
    s_add_u32 s3, s92, 344064
    s_add_u32 m0, s35, 4096
    s_nop 0
    buffer_load_dwordx4 v26, s[48:51], s3 offen lds
    s_add_u32 s3, s92, 352256
    s_add_u32 m0, s35, 5120
    s_nop 0
    buffer_load_dwordx4 v26, s[48:51], s3 offen lds
    ds_read_b64_tr_b16 a[8:9], v8 offset:27648
    ds_read_b64_tr_b16 a[10:11], v8 offset:28160
    ds_read_b64_tr_b16 a[12:13], v9 offset:27648
    ds_read_b64_tr_b16 a[14:15], v9 offset:28160
    s_waitcnt lgkmcnt(8)
    v_mfma_f32_32x32x16_bf16 v[80:95], a[20:23], v[100:103], v[80:95]
    v_mfma_f32_32x32x16_bf16 v[64:79], a[20:23], v[96:99], v[64:79]
    v_mfma_f32_32x32x16_bf16 v[48:63], a[16:19], v[100:103], v[48:63]
    v_mfma_f32_32x32x16_bf16 v[32:47], a[16:19], v[96:99], v[32:47]
    ds_read_b64_tr_b16 a[16:17], v8 offset:29696
    ds_read_b64_tr_b16 a[18:19], v8 offset:30208
    ds_read_b64_tr_b16 a[20:21], v9 offset:29696
    ds_read_b64_tr_b16 a[22:23], v9 offset:30208
    s_waitcnt lgkmcnt(8)
    v_mfma_f32_32x32x16_bf16 v[80:95], a[4:7], v[108:111], v[80:95]
    v_mfma_f32_32x32x16_bf16 v[64:79], a[4:7], v[104:107], v[64:79]
    v_mfma_f32_32x32x16_bf16 v[48:63], a[0:3], v[108:111], v[48:63]
    v_mfma_f32_32x32x16_bf16 v[32:47], a[0:3], v[104:107], v[32:47]
    s_waitcnt vmcnt(14)
    v_max3_u32 v13, v112, v116, v120
    v_max_u32 v13, v13, v124
    v_cmp_eq_u32 vcc, -1, v13
    s_cbranch_vccnz RT_59
BK_60:
    s_add_u32 s3, s6, 16384
    buffer_load_dwordx4 v[96:99], v3, s[24:27], s3 offen offset:0 sc1
    buffer_load_dwordx4 v[104:107], v3, s[24:27], s3 offen offset:1024 sc1
    s_add_u32 s3, s7, 16384
    buffer_load_dwordx4 v[100:103], v3, s[24:27], s3 offen offset:0 sc1
    buffer_load_dwordx4 v[108:111], v3, s[24:27], s3 offen offset:1024 sc1
    ds_read_b64_tr_b16 a[0:1], v14 offset:0
    ds_read_b64_tr_b16 a[2:3], v14 offset:512
    ds_read_b64_tr_b16 a[4:5], v15 offset:0
    ds_read_b64_tr_b16 a[6:7], v15 offset:512
    s_waitcnt lgkmcnt(8)
    v_mfma_f32_32x32x16_bf16 v[80:95], a[12:15], v[116:119], v[80:95]
    v_mfma_f32_32x32x16_bf16 v[64:79], a[12:15], v[112:115], v[64:79]
    v_mfma_f32_32x32x16_bf16 v[48:63], a[8:11], v[116:119], v[48:63]
    v_mfma_f32_32x32x16_bf16 v[32:47], a[8:11], v[112:115], v[32:47]
    ds_read_b64_tr_b16 a[8:9], v14 offset:2048
    ds_read_b64_tr_b16 a[10:11], v14 offset:2560
    ds_read_b64_tr_b16 a[12:13], v15 offset:2048
    ds_read_b64_tr_b16 a[14:15], v15 offset:2560
    s_waitcnt lgkmcnt(8)
    v_mfma_f32_32x32x16_bf16 v[80:95], a[20:23], v[124:127], v[80:95]
    v_mfma_f32_32x32x16_bf16 v[64:79], a[20:23], v[120:123], v[64:79]
    v_mfma_f32_32x32x16_bf16 v[48:63], a[16:19], v[124:127], v[48:63]
    v_mfma_f32_32x32x16_bf16 v[32:47], a[16:19], v[120:123], v[32:47]
    s_waitcnt vmcnt(12)
    v_max3_u32 v13, v128, v132, v136
    v_max_u32 v13, v13, v140
    v_cmp_eq_u32 vcc, -1, v13
    s_cbranch_vccnz RT_61
BK_62:
    s_add_u32 s3, s6, 18432
    buffer_load_dwordx4 v[112:115], v3, s[24:27], s3 offen offset:0 sc1
    buffer_load_dwordx4 v[120:123], v3, s[24:27], s3 offen offset:1024 sc1
    s_add_u32 s3, s7, 18432
    buffer_load_dwordx4 v[116:119], v3, s[24:27], s3 offen offset:0 sc1
    buffer_load_dwordx4 v[124:127], v3, s[24:27], s3 offen offset:1024 sc1
    ds_read_b64_tr_b16 a[16:17], v14 offset:4096
    ds_read_b64_tr_b16 a[18:19], v14 offset:4608
    ds_read_b64_tr_b16 a[20:21], v15 offset:4096
    ds_read_b64_tr_b16 a[22:23], v15 offset:4608
    s_waitcnt lgkmcnt(8)
    v_mfma_f32_32x32x16_bf16 v[80:95], a[4:7], v[132:135], v[80:95]
    v_mfma_f32_32x32x16_bf16 v[64:79], a[4:7], v[128:131], v[64:79]
    v_mfma_f32_32x32x16_bf16 v[48:63], a[0:3], v[132:135], v[48:63]
    v_mfma_f32_32x32x16_bf16 v[32:47], a[0:3], v[128:131], v[32:47]
    ds_read_b64_tr_b16 a[0:1], v14 offset:6144
    ds_read_b64_tr_b16 a[2:3], v14 offset:6656
    ds_read_b64_tr_b16 a[4:5], v15 offset:6144
    ds_read_b64_tr_b16 a[6:7], v15 offset:6656
    s_waitcnt lgkmcnt(8)
    v_mfma_f32_32x32x16_bf16 v[80:95], a[12:15], v[140:143], v[80:95]
    v_mfma_f32_32x32x16_bf16 v[64:79], a[12:15], v[136:139], v[64:79]
    v_mfma_f32_32x32x16_bf16 v[48:63], a[8:11], v[140:143], v[48:63]
    v_mfma_f32_32x32x16_bf16 v[32:47], a[8:11], v[136:139], v[32:47]
    s_waitcnt vmcnt(10)
    v_max3_u32 v13, v144, v148, v152
    v_max_u32 v13, v13, v156
    v_cmp_eq_u32 vcc, -1, v13
    s_cbranch_vccnz RT_63
BK_64:
    s_add_u32 s3, s6, 20480
    buffer_load_dwordx4 v[128:131], v3, s[24:27], s3 offen offset:0 sc1
    s_add_u32 s3, s3, s8
    buffer_load_dwordx4 v[136:139], v3, s[24:27], s3 offen offset:1024 sc1
    s_add_u32 s3, s7, 20480
    buffer_load_dwordx4 v[132:135], v3, s[24:27], s3 offen offset:0 sc1
    s_add_u32 s3, s3, s8
    buffer_load_dwordx4 v[140:143], v3, s[24:27], s3 offen offset:1024 sc1
    ds_read_b64_tr_b16 a[8:9], v14 offset:8192
    ds_read_b64_tr_b16 a[10:11], v14 offset:8704
    ds_read_b64_tr_b16 a[12:13], v15 offset:8192
    ds_read_b64_tr_b16 a[14:15], v15 offset:8704
    s_waitcnt lgkmcnt(8)
    v_mfma_f32_32x32x16_bf16 v[80:95], a[20:23], v[148:151], v[80:95]
    v_mfma_f32_32x32x16_bf16 v[64:79], a[20:23], v[144:147], v[64:79]
    v_mfma_f32_32x32x16_bf16 v[48:63], a[16:19], v[148:151], v[48:63]
    v_mfma_f32_32x32x16_bf16 v[32:47], a[16:19], v[144:147], v[32:47]
    ds_read_b64_tr_b16 a[16:17], v14 offset:10240
    ds_read_b64_tr_b16 a[18:19], v14 offset:10752
    ds_read_b64_tr_b16 a[20:21], v15 offset:10240
    ds_read_b64_tr_b16 a[22:23], v15 offset:10752
    s_waitcnt lgkmcnt(8)
    v_mfma_f32_32x32x16_bf16 v[80:95], a[4:7], v[156:159], v[80:95]
    v_mfma_f32_32x32x16_bf16 v[64:79], a[4:7], v[152:155], v[64:79]
    v_mfma_f32_32x32x16_bf16 v[48:63], a[0:3], v[156:159], v[48:63]
    v_mfma_f32_32x32x16_bf16 v[32:47], a[0:3], v[152:155], v[32:47]
    s_waitcnt vmcnt(8)
    v_max3_u32 v13, v96, v100, v104
    v_max_u32 v13, v13, v108
    v_cmp_eq_u32 vcc, -1, v13
    s_cbranch_vccnz RT_65
BK_66:
    ds_read_b64_tr_b16 a[0:1], v20 offset:0
    ds_read_b64_tr_b16 a[2:3], v20 offset:512
    ds_read_b64_tr_b16 a[4:5], v21 offset:0
    ds_read_b64_tr_b16 a[6:7], v21 offset:512
    s_waitcnt lgkmcnt(8)
    v_mfma_f32_32x32x16_bf16 v[80:95], a[12:15], v[100:103], v[80:95]
    v_mfma_f32_32x32x16_bf16 v[64:79], a[12:15], v[96:99], v[64:79]
    v_mfma_f32_32x32x16_bf16 v[48:63], a[8:11], v[100:103], v[48:63]
    v_mfma_f32_32x32x16_bf16 v[32:47], a[8:11], v[96:99], v[32:47]
    ds_read_b64_tr_b16 a[8:9], v8 offset:0
    ds_read_b64_tr_b16 a[10:11], v8 offset:512
    ds_read_b64_tr_b16 a[12:13], v9 offset:0
    ds_read_b64_tr_b16 a[14:15], v9 offset:512
    s_waitcnt lgkmcnt(8)
    v_mfma_f32_32x32x16_bf16 v[80:95], a[20:23], v[108:111], v[80:95]
    v_mfma_f32_32x32x16_bf16 v[64:79], a[20:23], v[104:107], v[64:79]
    v_mfma_f32_32x32x16_bf16 v[48:63], a[16:19], v[108:111], v[48:63]
    v_mfma_f32_32x32x16_bf16 v[32:47], a[16:19], v[104:107], v[32:47]
    s_waitcnt vmcnt(4)
    v_max3_u32 v13, v112, v116, v120
    v_max_u32 v13, v13, v124
    v_cmp_eq_u32 vcc, -1, v13
    s_cbranch_vccnz RT_67
BK_68:
    ds_read_b64_tr_b16 a[16:17], v8 offset:2048
    ds_read_b64_tr_b16 a[18:19], v8 offset:2560
    ds_read_b64_tr_b16 a[20:21], v9 offset:2048
    ds_read_b64_tr_b16 a[22:23], v9 offset:2560
    s_waitcnt lgkmcnt(8)
    v_mfma_f32_32x32x16_bf16 v[80:95], a[4:7], v[116:119], v[80:95]
    v_mfma_f32_32x32x16_bf16 v[64:79], a[4:7], v[112:115], v[64:79]
    v_mfma_f32_32x32x16_bf16 v[48:63], a[0:3], v[116:119], v[48:63]
    v_mfma_f32_32x32x16_bf16 v[32:47], a[0:3], v[112:115], v[32:47]
    ds_read_b64_tr_b16 a[0:1], v8 offset:4096
    ds_read_b64_tr_b16 a[2:3], v8 offset:4608
    ds_read_b64_tr_b16 a[4:5], v9 offset:4096
    ds_read_b64_tr_b16 a[6:7], v9 offset:4608
    s_waitcnt lgkmcnt(8)
    v_mfma_f32_32x32x16_bf16 v[80:95], a[12:15], v[124:127], v[80:95]
    v_mfma_f32_32x32x16_bf16 v[64:79], a[12:15], v[120:123], v[64:79]
    v_mfma_f32_32x32x16_bf16 v[48:63], a[8:11], v[124:127], v[48:63]
    v_mfma_f32_32x32x16_bf16 v[32:47], a[8:11], v[120:123], v[32:47]
    s_waitcnt vmcnt(0)
    v_max3_u32 v13, v128, v132, v136
    v_max_u32 v13, v13, v140
    v_cmp_eq_u32 vcc, -1, v13
    s_cbranch_vccnz RT_69
BK_70:
    s_waitcnt lgkmcnt(4)
    v_mfma_f32_32x32x16_bf16 v[80:95], a[20:23], v[132:135], v[80:95]
    v_mfma_f32_32x32x16_bf16 v[64:79], a[20:23], v[128:131], v[64:79]
    v_mfma_f32_32x32x16_bf16 v[48:63], a[16:19], v[132:135], v[48:63]
    v_mfma_f32_32x32x16_bf16 v[32:47], a[16:19], v[128:131], v[32:47]
    s_waitcnt lgkmcnt(0)
    s_barrier
    v_mfma_f32_32x32x16_bf16 v[80:95], a[4:7], v[140:143], v[80:95]
    v_mfma_f32_32x32x16_bf16 v[64:79], a[4:7], v[136:139], v[64:79]
    v_mfma_f32_32x32x16_bf16 v[48:63], a[0:3], v[140:143], v[48:63]
    v_mfma_f32_32x32x16_bf16 v[32:47], a[0:3], v[136:139], v[32:47]
    s_nop 8
    ds_write_b128 v18, v[80:83] offset:0
    ds_write_b128 v18, v[84:87] offset:1024
    ds_write_b128 v18, v[88:91] offset:2048
    ds_write_b128 v18, v[92:95] offset:3072
    ds_write_b128 v17, v[64:67] offset:0
    ds_write_b128 v17, v[68:71] offset:1024
    ds_write_b128 v17, v[72:75] offset:2048
    ds_write_b128 v17, v[76:79] offset:3072
    ds_write_b128 v16, v[48:51] offset:0
    ds_write_b128 v16, v[52:55] offset:1024
    ds_write_b128 v16, v[56:59] offset:2048
    ds_write_b128 v16, v[60:63] offset:3072
    s_waitcnt lgkmcnt(0)
    s_barrier
    ds_read_b128 v[96:99], v19 offset:0
    ds_read_b128 v[100:103], v19 offset:1024
    ds_read_b128 v[104:107], v19 offset:2048
    ds_read_b128 v[108:111], v19 offset:3072
    ds_read_b128 v[112:115], v19 offset:4096
    ds_read_b128 v[116:119], v19 offset:5120
    ds_read_b128 v[120:123], v19 offset:6144
    ds_read_b128 v[124:127], v19 offset:7168
    ds_read_b128 v[128:131], v19 offset:8192
    ds_read_b128 v[132:135], v19 offset:9216
    ds_read_b128 v[136:139], v19 offset:10240
    ds_read_b128 v[140:143], v19 offset:11264
    s_waitcnt lgkmcnt(11)
    v_add_f32 v32, v32, v96
    v_add_f32 v33, v33, v97
    v_add_f32 v34, v34, v98
    v_add_f32 v35, v35, v99
    s_waitcnt lgkmcnt(10)
    v_add_f32 v36, v36, v100
    v_add_f32 v37, v37, v101
    v_add_f32 v38, v38, v102
    v_add_f32 v39, v39, v103
    s_waitcnt lgkmcnt(9)
    v_add_f32 v40, v40, v104
    v_add_f32 v41, v41, v105
    v_add_f32 v42, v42, v106
    v_add_f32 v43, v43, v107
    s_waitcnt lgkmcnt(8)
    v_add_f32 v44, v44, v108
    v_add_f32 v45, v45, v109
    v_add_f32 v46, v46, v110
    v_add_f32 v47, v47, v111
    s_waitcnt lgkmcnt(7)
    v_add_f32 v32, v32, v112
    v_add_f32 v33, v33, v113
    v_add_f32 v34, v34, v114
    v_add_f32 v35, v35, v115
    s_waitcnt lgkmcnt(6)
    v_add_f32 v36, v36, v116
    v_add_f32 v37, v37, v117
    v_add_f32 v38, v38, v118
    v_add_f32 v39, v39, v119
    s_waitcnt lgkmcnt(5)
    v_add_f32 v40, v40, v120
    v_add_f32 v41, v41, v121
    v_add_f32 v42, v42, v122
    v_add_f32 v43, v43, v123
    s_waitcnt lgkmcnt(4)
    v_add_f32 v44, v44, v124
    v_add_f32 v45, v45, v125
    v_add_f32 v46, v46, v126
    v_add_f32 v47, v47, v127
    s_waitcnt lgkmcnt(3)
    v_add_f32 v32, v32, v128
    v_add_f32 v33, v33, v129
    v_add_f32 v34, v34, v130
    v_add_f32 v35, v35, v131
    s_waitcnt lgkmcnt(2)
    v_add_f32 v36, v36, v132
    v_add_f32 v37, v37, v133
    v_add_f32 v38, v38, v134
    v_add_f32 v39, v39, v135
    s_waitcnt lgkmcnt(1)
    v_add_f32 v40, v40, v136
    v_add_f32 v41, v41, v137
    v_add_f32 v42, v42, v138
    v_add_f32 v43, v43, v139
    s_waitcnt lgkmcnt(0)
    v_add_f32 v44, v44, v140
    v_add_f32 v45, v45, v141
    v_add_f32 v46, v46, v142
    v_add_f32 v47, v47, v143
    v_fma_f32 v32, v32, v224, v176
    v_fma_f32 v33, v33, v225, v177
    v_fma_f32 v34, v34, v226, v178
    v_fma_f32 v35, v35, v227, v179
    v_fma_f32 v36, v36, v228, v180
    v_fma_f32 v37, v37, v229, v181
    v_fma_f32 v38, v38, v230, v182
    v_fma_f32 v39, v39, v231, v183
    v_fma_f32 v40, v40, v232, v184
    v_fma_f32 v41, v41, v233, v185
    v_fma_f32 v42, v42, v234, v186
    v_fma_f32 v43, v43, v235, v187
    v_fma_f32 v44, v44, v236, v188
    v_fma_f32 v45, v45, v237, v189
    v_fma_f32 v46, v46, v238, v190
    v_fma_f32 v47, v47, v239, v191
    v_cvt_pk_bf16_f32 v64, v32, v33
    v_cvt_pk_bf16_f32 v65, v34, v35
    v_cvt_pk_bf16_f32 v66, v36, v37
    v_cvt_pk_bf16_f32 v67, v38, v39
    v_cvt_pk_bf16_f32 v68, v40, v41
    v_cvt_pk_bf16_f32 v69, v42, v43
    v_cvt_pk_bf16_f32 v70, v44, v45
    v_cvt_pk_bf16_f32 v71, v46, v47
    buffer_store_dwordx4 v[64:67], v27, s[52:55], s63 offen offset:0
    buffer_store_dwordx4 v[68:71], v27, s[52:55], s63 offen offset:32
L_END:
    s_endpgm
    s_nop 1
PM_9:
    s_cmp_ge_u32 s57, 100000
    s_cbranch_scc1 PMD_11
    buffer_load_dwordx4 v[40:43], v25, s[24:27], s4 offen sc1
    buffer_load_dwordx4 v[44:47], v25, s[24:27], s4 offen offset:16 sc1
    s_add_u32 s57, s57, 1
    s_waitcnt vmcnt(0)
    s_branch PMC_10
PA_12:
    s_cmp_ge_u32 s57, 100000
    s_cbranch_scc1 PAD_14
    s_add_u32 s3, s56, 0
    buffer_load_dwordx4 v[64:67], v3, s[24:27], s3 offen offset:0 sc1
    buffer_load_dwordx4 v[68:71], v3, s[24:27], s3 offen offset:1024 sc1
    s_add_u32 s3, s56, 4096
    buffer_load_dwordx4 v[72:75], v3, s[24:27], s3 offen offset:0 sc1
    buffer_load_dwordx4 v[76:79], v3, s[24:27], s3 offen offset:1024 sc1
    s_add_u32 s3, s56, 8192
    buffer_load_dwordx4 v[80:83], v3, s[24:27], s3 offen offset:0 sc1
    buffer_load_dwordx4 v[84:87], v3, s[24:27], s3 offen offset:1024 sc1
    s_add_u32 s3, s56, 12288
    buffer_load_dwordx4 v[88:91], v3, s[24:27], s3 offen offset:0 sc1
    buffer_load_dwordx4 v[92:95], v3, s[24:27], s3 offen offset:1024 sc1
    s_add_u32 s3, s56, 16384
    buffer_load_dwordx4 v[96:99], v3, s[24:27], s3 offen offset:0 sc1
    buffer_load_dwordx4 v[100:103], v3, s[24:27], s3 offen offset:1024 sc1
    s_add_u32 s3, s56, 20480
    buffer_load_dwordx4 v[104:107], v3, s[24:27], s3 offen offset:0 sc1
    buffer_load_dwordx4 v[108:111], v3, s[24:27], s3 offen offset:1024 sc1
    s_add_u32 s3, s56, 24576
    buffer_load_dwordx4 v[112:115], v3, s[24:27], s3 offen offset:0 sc1
    buffer_load_dwordx4 v[116:119], v3, s[24:27], s3 offen offset:1024 sc1
    s_add_u32 s3, s56, 28672
    buffer_load_dwordx4 v[120:123], v3, s[24:27], s3 offen offset:0 sc1
    buffer_load_dwordx4 v[124:127], v3, s[24:27], s3 offen offset:1024 sc1
    s_add_u32 s57, s57, 1
    s_waitcnt vmcnt(0)
    s_branch PAC_13
PD_15:
    s_cmp_ge_u32 s57, 100000
    s_cbranch_scc1 PDD_16
    buffer_load_dword v15, v14, s[24:27], s56 offen sc1
    s_add_u32 s57, s57, 1
    s_waitcnt vmcnt(0)
    v_cmp_ne_u32 vcc, v15, v12
    s_cbranch_vccnz PD_15
    s_branch PDD_16
    s_nop 2
RT_17:
    s_nop 7
    s_nop 7
    s_mov_b32 exec_lo, 0
    s_mov_b32 exec_hi, 0x80000000
RL_71:
    buffer_load_dwordx4 v[128:131], v3, s[24:27], s4 offen offset:0 sc1
    buffer_load_dwordx4 v[132:135], v3, s[24:27], s5 offen offset:0 sc1
    buffer_load_dwordx4 v[136:139], v3, s[24:27], s4 offen offset:1024 sc1
    buffer_load_dwordx4 v[140:143], v3, s[24:27], s5 offen offset:1024 sc1
    buffer_load_dwordx4 v[144:147], v3, s[24:27], s4 offen offset:2048 sc1
    buffer_load_dwordx4 v[148:151], v3, s[24:27], s5 offen offset:2048 sc1
    buffer_load_dwordx4 v[152:155], v3, s[24:27], s4 offen offset:3072 sc1
    buffer_load_dwordx4 v[156:159], v3, s[24:27], s5 offen offset:3072 sc1
    buffer_load_dwordx4 v[160:163], v3, s[24:27], s6 offen offset:0 sc1
    buffer_load_dwordx4 v[164:167], v3, s[24:27], s7 offen offset:0 sc1
    buffer_load_dwordx4 v[168:171], v3, s[24:27], s6 offen offset:1024 sc1
    buffer_load_dwordx4 v[172:175], v3, s[24:27], s7 offen offset:1024 sc1
    buffer_load_dwordx4 v[176:179], v3, s[24:27], s6 offen offset:2048 sc1
    buffer_load_dwordx4 v[180:183], v3, s[24:27], s7 offen offset:2048 sc1
    buffer_load_dwordx4 v[184:187], v3, s[24:27], s6 offen offset:3072 sc1
    buffer_load_dwordx4 v[188:191], v3, s[24:27], s7 offen offset:3072 sc1
    s_add_u32 s57, s57, 1
    s_waitcnt vmcnt(0)
    s_cmp_ge_u32 s57, 100000
    s_cbranch_scc1 RX_72
    v_max3_u32 v13, v128, v132, v136
    v_max3_u32 v13, v13, v140, v144
    v_max3_u32 v13, v13, v148, v152
    v_max3_u32 v13, v13, v156, v160
    v_max3_u32 v13, v13, v164, v168
    v_max3_u32 v13, v13, v172, v176
    v_max3_u32 v13, v13, v180, v184
    v_max_u32 v13, v13, v188
    v_cmp_eq_u32 vcc, -1, v13
    s_cbranch_vccnz RT_17
    s_cmp_eq_u32 exec_lo, -1
    s_mov_b64 exec, -1
    s_cbranch_scc0 RL_71
RX_72:
    s_mov_b64 exec, -1
    s_nop 3
    s_branch BK_18
RT_19:
    s_nop 7
    s_nop 7
    s_mov_b32 exec_lo, 0
    s_mov_b32 exec_hi, 0x80000000
RL_73:
    buffer_load_dwordx4 v[144:147], v3, s[24:27], s4 offen offset:2048 sc1
    buffer_load_dwordx4 v[148:151], v3, s[24:27], s5 offen offset:2048 sc1
    buffer_load_dwordx4 v[152:155], v3, s[24:27], s4 offen offset:3072 sc1
    buffer_load_dwordx4 v[156:159], v3, s[24:27], s5 offen offset:3072 sc1
    buffer_load_dwordx4 v[160:163], v3, s[24:27], s6 offen offset:0 sc1
    buffer_load_dwordx4 v[164:167], v3, s[24:27], s7 offen offset:0 sc1
    buffer_load_dwordx4 v[168:171], v3, s[24:27], s6 offen offset:1024 sc1
    buffer_load_dwordx4 v[172:175], v3, s[24:27], s7 offen offset:1024 sc1
    buffer_load_dwordx4 v[176:179], v3, s[24:27], s6 offen offset:2048 sc1
    buffer_load_dwordx4 v[180:183], v3, s[24:27], s7 offen offset:2048 sc1
    buffer_load_dwordx4 v[184:187], v3, s[24:27], s6 offen offset:3072 sc1
    buffer_load_dwordx4 v[188:191], v3, s[24:27], s7 offen offset:3072 sc1
    s_add_u32 s57, s57, 1
    s_waitcnt vmcnt(0)
    s_cmp_ge_u32 s57, 100000
    s_cbranch_scc1 RX_74
    v_max3_u32 v13, v144, v148, v152
    v_max3_u32 v13, v13, v156, v160
    v_max3_u32 v13, v13, v164, v168
    v_max3_u32 v13, v13, v172, v176
    v_max3_u32 v13, v13, v180, v184
    v_max_u32 v13, v13, v188
    v_cmp_eq_u32 vcc, -1, v13
    s_cbranch_vccnz RT_19
    s_cmp_eq_u32 exec_lo, -1
    s_mov_b64 exec, -1
    s_cbranch_scc0 RL_73
RX_74:
    s_mov_b64 exec, -1
    s_nop 3
    s_branch BK_20
RT_21:
    s_nop 7
    s_nop 7
    s_mov_b32 exec_lo, 0
    s_mov_b32 exec_hi, 0x80000000
RL_75:
    buffer_load_dwordx4 v[160:163], v3, s[24:27], s6 offen offset:0 sc1
    buffer_load_dwordx4 v[164:167], v3, s[24:27], s7 offen offset:0 sc1
    buffer_load_dwordx4 v[168:171], v3, s[24:27], s6 offen offset:1024 sc1
    buffer_load_dwordx4 v[172:175], v3, s[24:27], s7 offen offset:1024 sc1
    buffer_load_dwordx4 v[176:179], v3, s[24:27], s6 offen offset:2048 sc1
    buffer_load_dwordx4 v[180:183], v3, s[24:27], s7 offen offset:2048 sc1
    buffer_load_dwordx4 v[184:187], v3, s[24:27], s6 offen offset:3072 sc1
    buffer_load_dwordx4 v[188:191], v3, s[24:27], s7 offen offset:3072 sc1
    s_add_u32 s57, s57, 1
    s_waitcnt vmcnt(0)
    s_cmp_ge_u32 s57, 100000
    s_cbranch_scc1 RX_76
    v_max3_u32 v13, v160, v164, v168
    v_max3_u32 v13, v13, v172, v176
    v_max3_u32 v13, v13, v180, v184
    v_max_u32 v13, v13, v188
    v_cmp_eq_u32 vcc, -1, v13
    s_cbranch_vccnz RT_21
    s_cmp_eq_u32 exec_lo, -1
    s_mov_b64 exec, -1
    s_cbranch_scc0 RL_75
RX_76:
    s_mov_b64 exec, -1
    s_nop 3
    s_branch BK_22
RT_23:
    s_nop 7
    s_nop 7
    s_mov_b32 exec_lo, 0
    s_mov_b32 exec_hi, 0x80000000
RL_77:
    buffer_load_dwordx4 v[176:179], v3, s[24:27], s6 offen offset:2048 sc1
    buffer_load_dwordx4 v[180:183], v3, s[24:27], s7 offen offset:2048 sc1
    buffer_load_dwordx4 v[184:187], v3, s[24:27], s6 offen offset:3072 sc1
    buffer_load_dwordx4 v[188:191], v3, s[24:27], s7 offen offset:3072 sc1
    s_add_u32 s57, s57, 1
    s_waitcnt vmcnt(0)
    s_cmp_ge_u32 s57, 100000
    s_cbranch_scc1 RX_78
    v_max3_u32 v13, v176, v180, v184
    v_max_u32 v13, v13, v188
    v_cmp_eq_u32 vcc, -1, v13
    s_cbranch_vccnz RT_23
    s_cmp_eq_u32 exec_lo, -1
    s_mov_b64 exec, -1
    s_cbranch_scc0 RL_77
RX_78:
    s_mov_b64 exec, -1
    s_nop 3
    s_branch BK_24
PU_25:
    s_cmp_ge_u32 s57, 100000
    s_cbranch_scc1 PUD_27
    s_add_u32 s57, s57, 1
    s_add_u32 s3, s9, 0
    buffer_load_dwordx3 v[80:82], v11, s[24:27], s3 offen sc1
    s_add_u32 s3, s9, 3072
    buffer_load_dwordx3 v[84:86], v11, s[24:27], s3 offen sc1
    s_add_u32 s3, s9, 6144
    buffer_load_dwordx3 v[88:90], v11, s[24:27], s3 offen sc1
    s_add_u32 s3, s9, 9216
    buffer_load_dwordx3 v[92:94], v11, s[24:27], s3 offen sc1
    s_add_u32 s3, s9, 12288
    buffer_load_dwordx3 v[96:98], v11, s[24:27], s3 offen sc1
    s_add_u32 s3, s9, 15360
    buffer_load_dwordx3 v[100:102], v11, s[24:27], s3 offen sc1
    s_add_u32 s3, s9, 18432
    buffer_load_dwordx3 v[104:106], v11, s[24:27], s3 offen sc1
    s_add_u32 s3, s9, 21504
    buffer_load_dwordx3 v[108:110], v11, s[24:27], s3 offen sc1
    s_waitcnt vmcnt(0)
    s_branch PUC_26
RT_28:
    s_nop 7
    s_nop 7
    s_mov_b32 exec_lo, 0
    s_mov_b32 exec_hi, 0x80000000
RL_79:
    s_add_u32 s5, s8, 0
    s_and_b32 s5, s5, 7
    s_lshl_b32 s5, s5, 12
    s_add_u32 s5, s5, s6
    buffer_load_dwordx4 v[32:35], v3, s[24:27], s5 offen offset:0 sc1
    buffer_load_dwordx4 v[36:39], v3, s[24:27], s5 offen offset:1024 sc1
    buffer_load_dwordx4 v[40:43], v3, s[24:27], s5 offen offset:2048 sc1
    buffer_load_dwordx4 v[44:47], v3, s[24:27], s5 offen offset:3072 sc1
    s_add_u32 s5, s8, 1
    s_and_b32 s5, s5, 7
    s_lshl_b32 s5, s5, 12
    s_add_u32 s5, s5, s6
    buffer_load_dwordx4 v[48:51], v3, s[24:27], s5 offen offset:0 sc1
    buffer_load_dwordx4 v[52:55], v3, s[24:27], s5 offen offset:1024 sc1
    buffer_load_dwordx4 v[56:59], v3, s[24:27], s5 offen offset:2048 sc1
    buffer_load_dwordx4 v[60:63], v3, s[24:27], s5 offen offset:3072 sc1
    s_add_u32 s5, s8, 2
    s_and_b32 s5, s5, 7
    s_lshl_b32 s5, s5, 12
    s_add_u32 s5, s5, s6
    buffer_load_dwordx4 v[160:163], v3, s[24:27], s5 offen offset:0 sc1
    buffer_load_dwordx4 v[164:167], v3, s[24:27], s5 offen offset:1024 sc1
    buffer_load_dwordx4 v[168:171], v3, s[24:27], s5 offen offset:2048 sc1
    buffer_load_dwordx4 v[172:175], v3, s[24:27], s5 offen offset:3072 sc1
    s_add_u32 s57, s57, 1
    s_waitcnt vmcnt(0)
    s_cmp_ge_u32 s57, 100000
    s_cbranch_scc1 RX_80
    v_max3_u32 v13, v32, v36, v40
    v_max3_u32 v13, v13, v44, v48
    v_max3_u32 v13, v13, v52, v56
    v_max3_u32 v13, v13, v60, v160
    v_max3_u32 v13, v13, v164, v168
    v_max_u32 v13, v13, v172
    v_cmp_eq_u32 vcc, -1, v13
    s_cbranch_vccnz RT_28
    s_cmp_eq_u32 exec_lo, -1
    s_mov_b64 exec, -1
    s_cbranch_scc0 RL_79
RX_80:
    s_mov_b64 exec, -1
    s_nop 3
    s_branch BK_29
RT_30:
    s_nop 7
    s_nop 7
    s_mov_b32 exec_lo, 0
    s_mov_b32 exec_hi, 0x80000000
RL_81:
    s_add_u32 s5, s8, 1
    s_and_b32 s5, s5, 7
    s_lshl_b32 s5, s5, 12
    s_add_u32 s5, s5, s6
    buffer_load_dwordx4 v[48:51], v3, s[24:27], s5 offen offset:0 sc1
    buffer_load_dwordx4 v[52:55], v3, s[24:27], s5 offen offset:1024 sc1
    buffer_load_dwordx4 v[56:59], v3, s[24:27], s5 offen offset:2048 sc1
    buffer_load_dwordx4 v[60:63], v3, s[24:27], s5 offen offset:3072 sc1
    s_add_u32 s5, s8, 2
    s_and_b32 s5, s5, 7
    s_lshl_b32 s5, s5, 12
    s_add_u32 s5, s5, s6
    buffer_load_dwordx4 v[160:163], v3, s[24:27], s5 offen offset:0 sc1
    buffer_load_dwordx4 v[164:167], v3, s[24:27], s5 offen offset:1024 sc1
    buffer_load_dwordx4 v[168:171], v3, s[24:27], s5 offen offset:2048 sc1
    buffer_load_dwordx4 v[172:175], v3, s[24:27], s5 offen offset:3072 sc1
    s_add_u32 s57, s57, 1
    s_waitcnt vmcnt(0)
    s_cmp_ge_u32 s57, 100000
    s_cbranch_scc1 RX_82
    v_max3_u32 v13, v48, v52, v56
    v_max3_u32 v13, v13, v60, v160
    v_max3_u32 v13, v13, v164, v168
    v_max_u32 v13, v13, v172
    v_cmp_eq_u32 vcc, -1, v13
    s_cbranch_vccnz RT_30
    s_cmp_eq_u32 exec_lo, -1
    s_mov_b64 exec, -1
    s_cbranch_scc0 RL_81
RX_82:
    s_mov_b64 exec, -1
    s_nop 3
    s_branch BK_31
RT_32:
    s_nop 7
    s_nop 7
    s_mov_b32 exec_lo, 0
    s_mov_b32 exec_hi, 0x80000000
RL_83:
    s_add_u32 s5, s8, 2
    s_and_b32 s5, s5, 7
    s_lshl_b32 s5, s5, 12
    s_add_u32 s5, s5, s6
    buffer_load_dwordx4 v[160:163], v3, s[24:27], s5 offen offset:0 sc1
    buffer_load_dwordx4 v[164:167], v3, s[24:27], s5 offen offset:1024 sc1
    buffer_load_dwordx4 v[168:171], v3, s[24:27], s5 offen offset:2048 sc1
    buffer_load_dwordx4 v[172:175], v3, s[24:27], s5 offen offset:3072 sc1
    s_add_u32 s5, s8, 3
    s_and_b32 s5, s5, 7
    s_lshl_b32 s5, s5, 12
    s_add_u32 s5, s5, s6
    buffer_load_dwordx4 v[32:35], v3, s[24:27], s5 offen offset:0 sc1
    buffer_load_dwordx4 v[36:39], v3, s[24:27], s5 offen offset:1024 sc1
    buffer_load_dwordx4 v[40:43], v3, s[24:27], s5 offen offset:2048 sc1
    buffer_load_dwordx4 v[44:47], v3, s[24:27], s5 offen offset:3072 sc1
    s_add_u32 s57, s57, 1
    s_waitcnt vmcnt(0)
    s_cmp_ge_u32 s57, 100000
    s_cbranch_scc1 RX_84
    v_max3_u32 v13, v160, v164, v168
    v_max3_u32 v13, v13, v172, v32
    v_max3_u32 v13, v13, v36, v40
    v_max_u32 v13, v13, v44
    v_cmp_eq_u32 vcc, -1, v13
    s_cbranch_vccnz RT_32
    s_cmp_eq_u32 exec_lo, -1
    s_mov_b64 exec, -1
    s_cbranch_scc0 RL_83
RX_84:
    s_mov_b64 exec, -1
    s_nop 3
    s_branch BK_33
RT_34:
    s_nop 7
    s_nop 7
    s_mov_b32 exec_lo, 0
    s_mov_b32 exec_hi, 0x80000000
RL_85:
    s_add_u32 s5, s8, 3
    s_and_b32 s5, s5, 7
    s_lshl_b32 s5, s5, 12
    s_add_u32 s5, s5, s6
    buffer_load_dwordx4 v[32:35], v3, s[24:27], s5 offen offset:0 sc1
    buffer_load_dwordx4 v[36:39], v3, s[24:27], s5 offen offset:1024 sc1
    buffer_load_dwordx4 v[40:43], v3, s[24:27], s5 offen offset:2048 sc1
    buffer_load_dwordx4 v[44:47], v3, s[24:27], s5 offen offset:3072 sc1
    s_add_u32 s5, s8, 4
    s_and_b32 s5, s5, 7
    s_lshl_b32 s5, s5, 12
    s_add_u32 s5, s5, s6
    buffer_load_dwordx4 v[48:51], v3, s[24:27], s5 offen offset:0 sc1
    buffer_load_dwordx4 v[52:55], v3, s[24:27], s5 offen offset:1024 sc1
    buffer_load_dwordx4 v[56:59], v3, s[24:27], s5 offen offset:2048 sc1
    buffer_load_dwordx4 v[60:63], v3, s[24:27], s5 offen offset:3072 sc1
    s_add_u32 s57, s57, 1
    s_waitcnt vmcnt(0)
    s_cmp_ge_u32 s57, 100000
    s_cbranch_scc1 RX_86
    v_max3_u32 v13, v32, v36, v40
    v_max3_u32 v13, v13, v44, v48
    v_max3_u32 v13, v13, v52, v56
    v_max_u32 v13, v13, v60
    v_cmp_eq_u32 vcc, -1, v13
    s_cbranch_vccnz RT_34
    s_cmp_eq_u32 exec_lo, -1
    s_mov_b64 exec, -1
    s_cbranch_scc0 RL_85
RX_86:
    s_mov_b64 exec, -1
    s_nop 3
    s_branch BK_35
RT_36:
    s_nop 7
    s_nop 7
    s_mov_b32 exec_lo, 0
    s_mov_b32 exec_hi, 0x80000000
RL_87:
    s_add_u32 s5, s8, 4
    s_and_b32 s5, s5, 7
    s_lshl_b32 s5, s5, 12
    s_add_u32 s5, s5, s6
    buffer_load_dwordx4 v[48:51], v3, s[24:27], s5 offen offset:0 sc1
    buffer_load_dwordx4 v[52:55], v3, s[24:27], s5 offen offset:1024 sc1
    buffer_load_dwordx4 v[56:59], v3, s[24:27], s5 offen offset:2048 sc1
    buffer_load_dwordx4 v[60:63], v3, s[24:27], s5 offen offset:3072 sc1
    s_add_u32 s5, s8, 5
    s_and_b32 s5, s5, 7
    s_lshl_b32 s5, s5, 12
    s_add_u32 s5, s5, s6
    buffer_load_dwordx4 v[160:163], v3, s[24:27], s5 offen offset:0 sc1
    buffer_load_dwordx4 v[164:167], v3, s[24:27], s5 offen offset:1024 sc1
    buffer_load_dwordx4 v[168:171], v3, s[24:27], s5 offen offset:2048 sc1
    buffer_load_dwordx4 v[172:175], v3, s[24:27], s5 offen offset:3072 sc1
    s_add_u32 s57, s57, 1
    s_waitcnt vmcnt(0)
    s_cmp_ge_u32 s57, 100000
    s_cbranch_scc1 RX_88
    v_max3_u32 v13, v48, v52, v56
    v_max3_u32 v13, v13, v60, v160
    v_max3_u32 v13, v13, v164, v168
    v_max_u32 v13, v13, v172
    v_cmp_eq_u32 vcc, -1, v13
    s_cbranch_vccnz RT_36
    s_cmp_eq_u32 exec_lo, -1
    s_mov_b64 exec, -1
    s_cbranch_scc0 RL_87
RX_88:
    s_mov_b64 exec, -1
    s_nop 3
    s_branch BK_37
RT_38:
    s_nop 7
    s_nop 7
    s_mov_b32 exec_lo, 0
    s_mov_b32 exec_hi, 0x80000000
RL_89:
    s_add_u32 s5, s8, 5
    s_and_b32 s5, s5, 7
    s_lshl_b32 s5, s5, 12
    s_add_u32 s5, s5, s6
    buffer_load_dwordx4 v[160:163], v3, s[24:27], s5 offen offset:0 sc1
    buffer_load_dwordx4 v[164:167], v3, s[24:27], s5 offen offset:1024 sc1
    buffer_load_dwordx4 v[168:171], v3, s[24:27], s5 offen offset:2048 sc1
    buffer_load_dwordx4 v[172:175], v3, s[24:27], s5 offen offset:3072 sc1
    s_add_u32 s5, s8, 6
    s_and_b32 s5, s5, 7
    s_lshl_b32 s5, s5, 12
    s_add_u32 s5, s5, s6
    buffer_load_dwordx4 v[32:35], v3, s[24:27], s5 offen offset:0 sc1
    buffer_load_dwordx4 v[36:39], v3, s[24:27], s5 offen offset:1024 sc1
    buffer_load_dwordx4 v[40:43], v3, s[24:27], s5 offen offset:2048 sc1
    buffer_load_dwordx4 v[44:47], v3, s[24:27], s5 offen offset:3072 sc1
    s_add_u32 s57, s57, 1
    s_waitcnt vmcnt(0)
    s_cmp_ge_u32 s57, 100000
    s_cbranch_scc1 RX_90
    v_max3_u32 v13, v160, v164, v168
    v_max3_u32 v13, v13, v172, v32
    v_max3_u32 v13, v13, v36, v40
    v_max_u32 v13, v13, v44
    v_cmp_eq_u32 vcc, -1, v13
    s_cbranch_vccnz RT_38
    s_cmp_eq_u32 exec_lo, -1
    s_mov_b64 exec, -1
    s_cbranch_scc0 RL_89
RX_90:
    s_mov_b64 exec, -1
    s_nop 3
    s_branch BK_39
RT_40:
    s_nop 7
    s_nop 7
    s_mov_b32 exec_lo, 0
    s_mov_b32 exec_hi, 0x80000000
RL_91:
    s_add_u32 s5, s8, 6
    s_and_b32 s5, s5, 7
    s_lshl_b32 s5, s5, 12
    s_add_u32 s5, s5, s6
    buffer_load_dwordx4 v[32:35], v3, s[24:27], s5 offen offset:0 sc1
    buffer_load_dwordx4 v[36:39], v3, s[24:27], s5 offen offset:1024 sc1
    buffer_load_dwordx4 v[40:43], v3, s[24:27], s5 offen offset:2048 sc1
    buffer_load_dwordx4 v[44:47], v3, s[24:27], s5 offen offset:3072 sc1
    s_add_u32 s5, s8, 7
    s_and_b32 s5, s5, 7
    s_lshl_b32 s5, s5, 12
    s_add_u32 s5, s5, s6
    buffer_load_dwordx4 v[48:51], v3, s[24:27], s5 offen offset:0 sc1
    buffer_load_dwordx4 v[52:55], v3, s[24:27], s5 offen offset:1024 sc1
    buffer_load_dwordx4 v[56:59], v3, s[24:27], s5 offen offset:2048 sc1
    buffer_load_dwordx4 v[60:63], v3, s[24:27], s5 offen offset:3072 sc1
    s_add_u32 s57, s57, 1
    s_waitcnt vmcnt(0)
    s_cmp_ge_u32 s57, 100000
    s_cbranch_scc1 RX_92
    v_max3_u32 v13, v32, v36, v40
    v_max3_u32 v13, v13, v44, v48
    v_max3_u32 v13, v13, v52, v56
    v_max_u32 v13, v13, v60
    v_cmp_eq_u32 vcc, -1, v13
    s_cbranch_vccnz RT_40
    s_cmp_eq_u32 exec_lo, -1
    s_mov_b64 exec, -1
    s_cbranch_scc0 RL_91
RX_92:
    s_mov_b64 exec, -1
    s_nop 3
    s_branch BK_41
RT_42:
    s_nop 7
    s_nop 7
    s_mov_b32 exec_lo, 0
    s_mov_b64 exec, -1
RL_93:
    s_add_u32 s3, s7, 0
    buffer_load_dwordx4 v[192:195], v10, s[24:27], s3 offen sc1
    s_add_u32 s3, s7, 65536
    buffer_load_dwordx4 v[196:199], v10, s[24:27], s3 offen sc1
    s_add_u32 s3, s7, 131072
    buffer_load_dwordx4 v[200:203], v10, s[24:27], s3 offen sc1
    s_add_u32 s3, s7, 196608
    buffer_load_dwordx4 v[204:207], v10, s[24:27], s3 offen sc1
    s_add_u32 s57, s57, 1
    s_waitcnt vmcnt(0)
    s_cmp_ge_u32 s57, 100000
    s_cbranch_scc1 RX_94
    v_max3_u32 v208, v192, v193, v194
    v_max3_u32 v208, v208, v195, v196
    v_max3_u32 v208, v208, v197, v198
    v_max3_u32 v208, v208, v199, v200
    v_max3_u32 v208, v208, v201, v202
    v_max3_u32 v208, v208, v203, v204
    v_max3_u32 v208, v208, v205, v206
    v_max_u32 v208, v208, v207
    v_cmp_eq_u32 vcc, -1, v208
    s_cbranch_vccnz RT_42
    s_cmp_eq_u32 exec_lo, -1
    s_mov_b64 exec, -1
    s_cbranch_scc0 RL_93
RX_94:
    s_mov_b64 exec, -1
    s_nop 3
    s_branch BK_43
RT_44:
    s_nop 7
    s_nop 7
    s_mov_b32 exec_lo, 0
    s_mov_b32 exec_hi, 0x80000000
RL_95:
    s_add_u32 s5, s8, 7
    s_and_b32 s5, s5, 7
    s_lshl_b32 s5, s5, 12
    s_add_u32 s5, s5, s6
    buffer_load_dwordx4 v[48:51], v3, s[24:27], s5 offen offset:0 sc1
    buffer_load_dwordx4 v[52:55], v3, s[24:27], s5 offen offset:1024 sc1
    buffer_load_dwordx4 v[56:59], v3, s[24:27], s5 offen offset:2048 sc1
    buffer_load_dwordx4 v[60:63], v3, s[24:27], s5 offen offset:3072 sc1
    s_add_u32 s57, s57, 1
    s_waitcnt vmcnt(0)
    s_cmp_ge_u32 s57, 100000
    s_cbranch_scc1 RX_96
    v_max3_u32 v13, v48, v52, v56
    v_max_u32 v13, v13, v60
    v_cmp_eq_u32 vcc, -1, v13
    s_cbranch_vccnz RT_44
    s_cmp_eq_u32 exec_lo, -1
    s_mov_b64 exec, -1
    s_cbranch_scc0 RL_95
RX_96:
    s_mov_b64 exec, -1
    s_nop 3
    s_branch BK_45
PG_46:
    s_cmp_ge_u32 s57, 100000
    s_cbranch_scc1 PGD_48
    s_add_u32 s57, s57, 1
    buffer_load_dwordx4 v[192:195], v25, s[24:27], s9 offen offset:0 sc1
    buffer_load_dwordx4 v[196:199], v25, s[24:27], s9 offen offset:16 sc1
    s_waitcnt vmcnt(0)
    s_branch PGC_47
RT_49:
    s_nop 7
    s_nop 7
    s_mov_b32 exec_lo, 0
    s_mov_b32 exec_hi, 0x80000000
RL_97:
    s_add_u32 s3, s6, 0
    buffer_load_dwordx4 v[96:99], v3, s[24:27], s3 offen offset:0 sc1
    buffer_load_dwordx4 v[104:107], v3, s[24:27], s3 offen offset:1024 sc1
    s_add_u32 s3, s7, 0
    buffer_load_dwordx4 v[100:103], v3, s[24:27], s3 offen offset:0 sc1
    buffer_load_dwordx4 v[108:111], v3, s[24:27], s3 offen offset:1024 sc1
    s_add_u32 s3, s6, 2048
    buffer_load_dwordx4 v[112:115], v3, s[24:27], s3 offen offset:0 sc1
    buffer_load_dwordx4 v[120:123], v3, s[24:27], s3 offen offset:1024 sc1
    s_add_u32 s3, s7, 2048
    buffer_load_dwordx4 v[116:119], v3, s[24:27], s3 offen offset:0 sc1
    buffer_load_dwordx4 v[124:127], v3, s[24:27], s3 offen offset:1024 sc1
    s_add_u32 s3, s6, 4096
    buffer_load_dwordx4 v[128:131], v3, s[24:27], s3 offen offset:0 sc1
    buffer_load_dwordx4 v[136:139], v3, s[24:27], s3 offen offset:1024 sc1
    s_add_u32 s3, s7, 4096
    buffer_load_dwordx4 v[132:135], v3, s[24:27], s3 offen offset:0 sc1
    buffer_load_dwordx4 v[140:143], v3, s[24:27], s3 offen offset:1024 sc1
    s_add_u32 s57, s57, 1
    s_waitcnt vmcnt(0)
    s_cmp_ge_u32 s57, 100000
    s_cbranch_scc1 RX_98
    v_max3_u32 v13, v96, v100, v104
    v_max3_u32 v13, v13, v108, v112
    v_max3_u32 v13, v13, v116, v120
    v_max3_u32 v13, v13, v124, v128
    v_max3_u32 v13, v13, v132, v136
    v_max_u32 v13, v13, v140
    v_cmp_eq_u32 vcc, -1, v13
    s_cbranch_vccnz RT_49
    s_cmp_eq_u32 exec_lo, -1
    s_mov_b64 exec, -1
    s_cbranch_scc0 RL_97
RX_98:
    s_mov_b64 exec, -1
    s_nop 3
    s_branch BK_50
RT_51:
    s_nop 7
    s_nop 7
    s_mov_b32 exec_lo, 0
    s_mov_b32 exec_hi, 0x80000000
RL_99:
    s_add_u32 s3, s6, 2048
    buffer_load_dwordx4 v[112:115], v3, s[24:27], s3 offen offset:0 sc1
    buffer_load_dwordx4 v[120:123], v3, s[24:27], s3 offen offset:1024 sc1
    s_add_u32 s3, s7, 2048
    buffer_load_dwordx4 v[116:119], v3, s[24:27], s3 offen offset:0 sc1
    buffer_load_dwordx4 v[124:127], v3, s[24:27], s3 offen offset:1024 sc1
    s_add_u32 s3, s6, 4096
    buffer_load_dwordx4 v[128:131], v3, s[24:27], s3 offen offset:0 sc1
    buffer_load_dwordx4 v[136:139], v3, s[24:27], s3 offen offset:1024 sc1
    s_add_u32 s3, s7, 4096
    buffer_load_dwordx4 v[132:135], v3, s[24:27], s3 offen offset:0 sc1
    buffer_load_dwordx4 v[140:143], v3, s[24:27], s3 offen offset:1024 sc1
    s_add_u32 s3, s6, 6144
    buffer_load_dwordx4 v[144:147], v3, s[24:27], s3 offen offset:0 sc1
    buffer_load_dwordx4 v[152:155], v3, s[24:27], s3 offen offset:1024 sc1
    s_add_u32 s3, s7, 6144
    buffer_load_dwordx4 v[148:151], v3, s[24:27], s3 offen offset:0 sc1
    buffer_load_dwordx4 v[156:159], v3, s[24:27], s3 offen offset:1024 sc1
    s_add_u32 s57, s57, 1
    s_waitcnt vmcnt(0)
    s_cmp_ge_u32 s57, 100000
    s_cbranch_scc1 RX_100
    v_max3_u32 v13, v112, v116, v120
    v_max3_u32 v13, v13, v124, v128
    v_max3_u32 v13, v13, v132, v136
    v_max3_u32 v13, v13, v140, v144
    v_max3_u32 v13, v13, v148, v152
    v_max_u32 v13, v13, v156
    v_cmp_eq_u32 vcc, -1, v13
    s_cbranch_vccnz RT_51
    s_cmp_eq_u32 exec_lo, -1
    s_mov_b64 exec, -1
    s_cbranch_scc0 RL_99
RX_100:
    s_mov_b64 exec, -1
    s_nop 3
    s_branch BK_52
RT_53:
    s_nop 7
    s_nop 7
    s_mov_b32 exec_lo, 0
    s_mov_b32 exec_hi, 0x80000000
RL_101:
    s_add_u32 s3, s6, 4096
    buffer_load_dwordx4 v[128:131], v3, s[24:27], s3 offen offset:0 sc1
    buffer_load_dwordx4 v[136:139], v3, s[24:27], s3 offen offset:1024 sc1
    s_add_u32 s3, s7, 4096
    buffer_load_dwordx4 v[132:135], v3, s[24:27], s3 offen offset:0 sc1
    buffer_load_dwordx4 v[140:143], v3, s[24:27], s3 offen offset:1024 sc1
    s_add_u32 s3, s6, 6144
    buffer_load_dwordx4 v[144:147], v3, s[24:27], s3 offen offset:0 sc1
    buffer_load_dwordx4 v[152:155], v3, s[24:27], s3 offen offset:1024 sc1
    s_add_u32 s3, s7, 6144
    buffer_load_dwordx4 v[148:151], v3, s[24:27], s3 offen offset:0 sc1
    buffer_load_dwordx4 v[156:159], v3, s[24:27], s3 offen offset:1024 sc1
    s_add_u32 s3, s6, 8192
    buffer_load_dwordx4 v[96:99], v3, s[24:27], s3 offen offset:0 sc1
    buffer_load_dwordx4 v[104:107], v3, s[24:27], s3 offen offset:1024 sc1
    s_add_u32 s3, s7, 8192
    buffer_load_dwordx4 v[100:103], v3, s[24:27], s3 offen offset:0 sc1
    buffer_load_dwordx4 v[108:111], v3, s[24:27], s3 offen offset:1024 sc1
    s_add_u32 s57, s57, 1
    s_waitcnt vmcnt(0)
    s_cmp_ge_u32 s57, 100000
    s_cbranch_scc1 RX_102
    v_max3_u32 v13, v128, v132, v136
    v_max3_u32 v13, v13, v140, v144
    v_max3_u32 v13, v13, v148, v152
    v_max3_u32 v13, v13, v156, v96
    v_max3_u32 v13, v13, v100, v104
    v_max_u32 v13, v13, v108
    v_cmp_eq_u32 vcc, -1, v13
    s_cbranch_vccnz RT_53
    s_cmp_eq_u32 exec_lo, -1
    s_mov_b64 exec, -1
    s_cbranch_scc0 RL_101
RX_102:
    s_mov_b64 exec, -1
    s_nop 3
    s_branch BK_54
RT_55:
    s_nop 7
    s_nop 7
    s_mov_b32 exec_lo, 0
    s_mov_b32 exec_hi, 0x80000000
RL_103:
    s_add_u32 s3, s6, 6144
    buffer_load_dwordx4 v[144:147], v3, s[24:27], s3 offen offset:0 sc1
    buffer_load_dwordx4 v[152:155], v3, s[24:27], s3 offen offset:1024 sc1
    s_add_u32 s3, s7, 6144
    buffer_load_dwordx4 v[148:151], v3, s[24:27], s3 offen offset:0 sc1
    buffer_load_dwordx4 v[156:159], v3, s[24:27], s3 offen offset:1024 sc1
    s_add_u32 s3, s6, 8192
    buffer_load_dwordx4 v[96:99], v3, s[24:27], s3 offen offset:0 sc1
    buffer_load_dwordx4 v[104:107], v3, s[24:27], s3 offen offset:1024 sc1
    s_add_u32 s3, s7, 8192
    buffer_load_dwordx4 v[100:103], v3, s[24:27], s3 offen offset:0 sc1
    buffer_load_dwordx4 v[108:111], v3, s[24:27], s3 offen offset:1024 sc1
    s_add_u32 s3, s6, 10240
    buffer_load_dwordx4 v[112:115], v3, s[24:27], s3 offen offset:0 sc1
    buffer_load_dwordx4 v[120:123], v3, s[24:27], s3 offen offset:1024 sc1
    s_add_u32 s3, s7, 10240
    buffer_load_dwordx4 v[116:119], v3, s[24:27], s3 offen offset:0 sc1
    buffer_load_dwordx4 v[124:127], v3, s[24:27], s3 offen offset:1024 sc1
    s_add_u32 s57, s57, 1
    s_waitcnt vmcnt(0)
    s_cmp_ge_u32 s57, 100000
    s_cbranch_scc1 RX_104
    v_max3_u32 v13, v144, v148, v152
    v_max3_u32 v13, v13, v156, v96
    v_max3_u32 v13, v13, v100, v104
    v_max3_u32 v13, v13, v108, v112
    v_max3_u32 v13, v13, v116, v120
    v_max_u32 v13, v13, v124
    v_cmp_eq_u32 vcc, -1, v13
    s_cbranch_vccnz RT_55
    s_cmp_eq_u32 exec_lo, -1
    s_mov_b64 exec, -1
    s_cbranch_scc0 RL_103
RX_104:
    s_mov_b64 exec, -1
    s_nop 3
    s_branch BK_56
RT_57:
    s_nop 7
    s_nop 7
    s_mov_b32 exec_lo, 0
    s_mov_b32 exec_hi, 0x80000000
RL_105:
    s_add_u32 s3, s6, 8192
    buffer_load_dwordx4 v[96:99], v3, s[24:27], s3 offen offset:0 sc1
    buffer_load_dwordx4 v[104:107], v3, s[24:27], s3 offen offset:1024 sc1
    s_add_u32 s3, s7, 8192
    buffer_load_dwordx4 v[100:103], v3, s[24:27], s3 offen offset:0 sc1
    buffer_load_dwordx4 v[108:111], v3, s[24:27], s3 offen offset:1024 sc1
    s_add_u32 s3, s6, 10240
    buffer_load_dwordx4 v[112:115], v3, s[24:27], s3 offen offset:0 sc1
    buffer_load_dwordx4 v[120:123], v3, s[24:27], s3 offen offset:1024 sc1
    s_add_u32 s3, s7, 10240
    buffer_load_dwordx4 v[116:119], v3, s[24:27], s3 offen offset:0 sc1
    buffer_load_dwordx4 v[124:127], v3, s[24:27], s3 offen offset:1024 sc1
    s_add_u32 s3, s6, 12288
    buffer_load_dwordx4 v[128:131], v3, s[24:27], s3 offen offset:0 sc1
    buffer_load_dwordx4 v[136:139], v3, s[24:27], s3 offen offset:1024 sc1
    s_add_u32 s3, s7, 12288
    buffer_load_dwordx4 v[132:135], v3, s[24:27], s3 offen offset:0 sc1
    buffer_load_dwordx4 v[140:143], v3, s[24:27], s3 offen offset:1024 sc1
    s_add_u32 s57, s57, 1
    s_waitcnt vmcnt(0)
    s_cmp_ge_u32 s57, 100000
    s_cbranch_scc1 RX_106
    v_max3_u32 v13, v96, v100, v104
    v_max3_u32 v13, v13, v108, v112
    v_max3_u32 v13, v13, v116, v120
    v_max3_u32 v13, v13, v124, v128
    v_max3_u32 v13, v13, v132, v136
    v_max_u32 v13, v13, v140
    v_cmp_eq_u32 vcc, -1, v13
    s_cbranch_vccnz RT_57
    s_cmp_eq_u32 exec_lo, -1
    s_mov_b64 exec, -1
    s_cbranch_scc0 RL_105
RX_106:
    s_mov_b64 exec, -1
    s_nop 3
    s_branch BK_58
RT_59:
    s_nop 7
    s_nop 7
    s_mov_b32 exec_lo, 0
    s_mov_b32 exec_hi, 0x80000000
RL_107:
    s_add_u32 s3, s6, 10240
    buffer_load_dwordx4 v[112:115], v3, s[24:27], s3 offen offset:0 sc1
    buffer_load_dwordx4 v[120:123], v3, s[24:27], s3 offen offset:1024 sc1
    s_add_u32 s3, s7, 10240
    buffer_load_dwordx4 v[116:119], v3, s[24:27], s3 offen offset:0 sc1
    buffer_load_dwordx4 v[124:127], v3, s[24:27], s3 offen offset:1024 sc1
    s_add_u32 s3, s6, 12288
    buffer_load_dwordx4 v[128:131], v3, s[24:27], s3 offen offset:0 sc1
    buffer_load_dwordx4 v[136:139], v3, s[24:27], s3 offen offset:1024 sc1
    s_add_u32 s3, s7, 12288
    buffer_load_dwordx4 v[132:135], v3, s[24:27], s3 offen offset:0 sc1
    buffer_load_dwordx4 v[140:143], v3, s[24:27], s3 offen offset:1024 sc1
    s_add_u32 s3, s6, 14336
    buffer_load_dwordx4 v[144:147], v3, s[24:27], s3 offen offset:0 sc1
    buffer_load_dwordx4 v[152:155], v3, s[24:27], s3 offen offset:1024 sc1
    s_add_u32 s3, s7, 14336
    buffer_load_dwordx4 v[148:151], v3, s[24:27], s3 offen offset:0 sc1
    buffer_load_dwordx4 v[156:159], v3, s[24:27], s3 offen offset:1024 sc1
    s_add_u32 s57, s57, 1
    s_waitcnt vmcnt(0)
    s_cmp_ge_u32 s57, 100000
    s_cbranch_scc1 RX_108
    v_max3_u32 v13, v112, v116, v120
    v_max3_u32 v13, v13, v124, v128
    v_max3_u32 v13, v13, v132, v136
    v_max3_u32 v13, v13, v140, v144
    v_max3_u32 v13, v13, v148, v152
    v_max_u32 v13, v13, v156
    v_cmp_eq_u32 vcc, -1, v13
    s_cbranch_vccnz RT_59
    s_cmp_eq_u32 exec_lo, -1
    s_mov_b64 exec, -1
    s_cbranch_scc0 RL_107
RX_108:
    s_mov_b64 exec, -1
    s_nop 3
    s_branch BK_60
RT_61:
    s_nop 7
    s_nop 7
    s_mov_b32 exec_lo, 0
    s_mov_b32 exec_hi, 0x80000000
RL_109:
    s_add_u32 s3, s6, 12288
    buffer_load_dwordx4 v[128:131], v3, s[24:27], s3 offen offset:0 sc1
    buffer_load_dwordx4 v[136:139], v3, s[24:27], s3 offen offset:1024 sc1
    s_add_u32 s3, s7, 12288
    buffer_load_dwordx4 v[132:135], v3, s[24:27], s3 offen offset:0 sc1
    buffer_load_dwordx4 v[140:143], v3, s[24:27], s3 offen offset:1024 sc1
    s_add_u32 s3, s6, 14336
    buffer_load_dwordx4 v[144:147], v3, s[24:27], s3 offen offset:0 sc1
    buffer_load_dwordx4 v[152:155], v3, s[24:27], s3 offen offset:1024 sc1
    s_add_u32 s3, s7, 14336
    buffer_load_dwordx4 v[148:151], v3, s[24:27], s3 offen offset:0 sc1
    buffer_load_dwordx4 v[156:159], v3, s[24:27], s3 offen offset:1024 sc1
    s_add_u32 s3, s6, 16384
    buffer_load_dwordx4 v[96:99], v3, s[24:27], s3 offen offset:0 sc1
    buffer_load_dwordx4 v[104:107], v3, s[24:27], s3 offen offset:1024 sc1
    s_add_u32 s3, s7, 16384
    buffer_load_dwordx4 v[100:103], v3, s[24:27], s3 offen offset:0 sc1
    buffer_load_dwordx4 v[108:111], v3, s[24:27], s3 offen offset:1024 sc1
    s_add_u32 s57, s57, 1
    s_waitcnt vmcnt(0)
    s_cmp_ge_u32 s57, 100000
    s_cbranch_scc1 RX_110
    v_max3_u32 v13, v128, v132, v136
    v_max3_u32 v13, v13, v140, v144
    v_max3_u32 v13, v13, v148, v152
    v_max3_u32 v13, v13, v156, v96
    v_max3_u32 v13, v13, v100, v104
    v_max_u32 v13, v13, v108
    v_cmp_eq_u32 vcc, -1, v13
    s_cbranch_vccnz RT_61
    s_cmp_eq_u32 exec_lo, -1
    s_mov_b64 exec, -1
    s_cbranch_scc0 RL_109
RX_110:
    s_mov_b64 exec, -1
    s_nop 3
    s_branch BK_62
RT_63:
    s_nop 7
    s_nop 7
    s_mov_b32 exec_lo, 0
    s_mov_b32 exec_hi, 0x80000000
RL_111:
    s_add_u32 s3, s6, 14336
    buffer_load_dwordx4 v[144:147], v3, s[24:27], s3 offen offset:0 sc1
    buffer_load_dwordx4 v[152:155], v3, s[24:27], s3 offen offset:1024 sc1
    s_add_u32 s3, s7, 14336
    buffer_load_dwordx4 v[148:151], v3, s[24:27], s3 offen offset:0 sc1
    buffer_load_dwordx4 v[156:159], v3, s[24:27], s3 offen offset:1024 sc1
    s_add_u32 s3, s6, 16384
    buffer_load_dwordx4 v[96:99], v3, s[24:27], s3 offen offset:0 sc1
    buffer_load_dwordx4 v[104:107], v3, s[24:27], s3 offen offset:1024 sc1
    s_add_u32 s3, s7, 16384
    buffer_load_dwordx4 v[100:103], v3, s[24:27], s3 offen offset:0 sc1
    buffer_load_dwordx4 v[108:111], v3, s[24:27], s3 offen offset:1024 sc1
    s_add_u32 s3, s6, 18432
    buffer_load_dwordx4 v[112:115], v3, s[24:27], s3 offen offset:0 sc1
    buffer_load_dwordx4 v[120:123], v3, s[24:27], s3 offen offset:1024 sc1
    s_add_u32 s3, s7, 18432
    buffer_load_dwordx4 v[116:119], v3, s[24:27], s3 offen offset:0 sc1
    buffer_load_dwordx4 v[124:127], v3, s[24:27], s3 offen offset:1024 sc1
    s_add_u32 s57, s57, 1
    s_waitcnt vmcnt(0)
    s_cmp_ge_u32 s57, 100000
    s_cbranch_scc1 RX_112
    v_max3_u32 v13, v144, v148, v152
    v_max3_u32 v13, v13, v156, v96
    v_max3_u32 v13, v13, v100, v104
    v_max3_u32 v13, v13, v108, v112
    v_max3_u32 v13, v13, v116, v120
    v_max_u32 v13, v13, v124
    v_cmp_eq_u32 vcc, -1, v13
    s_cbranch_vccnz RT_63
    s_cmp_eq_u32 exec_lo, -1
    s_mov_b64 exec, -1
    s_cbranch_scc0 RL_111
RX_112:
    s_mov_b64 exec, -1
    s_nop 3
    s_branch BK_64
RT_65:
    s_nop 7
    s_nop 7
    s_mov_b32 exec_lo, 0
    s_mov_b32 exec_hi, 0x80000000
RL_113:
    s_add_u32 s3, s6, 16384
    buffer_load_dwordx4 v[96:99], v3, s[24:27], s3 offen offset:0 sc1
    buffer_load_dwordx4 v[104:107], v3, s[24:27], s3 offen offset:1024 sc1
    s_add_u32 s3, s7, 16384
    buffer_load_dwordx4 v[100:103], v3, s[24:27], s3 offen offset:0 sc1
    buffer_load_dwordx4 v[108:111], v3, s[24:27], s3 offen offset:1024 sc1
    s_add_u32 s3, s6, 18432
    buffer_load_dwordx4 v[112:115], v3, s[24:27], s3 offen offset:0 sc1
    buffer_load_dwordx4 v[120:123], v3, s[24:27], s3 offen offset:1024 sc1
    s_add_u32 s3, s7, 18432
    buffer_load_dwordx4 v[116:119], v3, s[24:27], s3 offen offset:0 sc1
    buffer_load_dwordx4 v[124:127], v3, s[24:27], s3 offen offset:1024 sc1
    s_add_u32 s3, s6, 20480
    buffer_load_dwordx4 v[128:131], v3, s[24:27], s3 offen offset:0 sc1
    s_add_u32 s3, s3, s8
    buffer_load_dwordx4 v[136:139], v3, s[24:27], s3 offen offset:1024 sc1
    s_add_u32 s3, s7, 20480
    buffer_load_dwordx4 v[132:135], v3, s[24:27], s3 offen offset:0 sc1
    s_add_u32 s3, s3, s8
    buffer_load_dwordx4 v[140:143], v3, s[24:27], s3 offen offset:1024 sc1
    s_add_u32 s57, s57, 1
    s_waitcnt vmcnt(0)
    s_cmp_ge_u32 s57, 100000
    s_cbranch_scc1 RX_114
    v_max3_u32 v13, v96, v100, v104
    v_max3_u32 v13, v13, v108, v112
    v_max3_u32 v13, v13, v116, v120
    v_max3_u32 v13, v13, v124, v128
    v_max3_u32 v13, v13, v132, v136
    v_max_u32 v13, v13, v140
    v_cmp_eq_u32 vcc, -1, v13
    s_cbranch_vccnz RT_65
    s_cmp_eq_u32 exec_lo, -1
    s_mov_b64 exec, -1
    s_cbranch_scc0 RL_113
RX_114:
    s_mov_b64 exec, -1
    s_nop 3
    s_branch BK_66
RT_67:
    s_nop 7
    s_nop 7
    s_mov_b32 exec_lo, 0
    s_mov_b32 exec_hi, 0x80000000
RL_115:
    s_add_u32 s3, s6, 18432
    buffer_load_dwordx4 v[112:115], v3, s[24:27], s3 offen offset:0 sc1
    buffer_load_dwordx4 v[120:123], v3, s[24:27], s3 offen offset:1024 sc1
    s_add_u32 s3, s7, 18432
    buffer_load_dwordx4 v[116:119], v3, s[24:27], s3 offen offset:0 sc1
    buffer_load_dwordx4 v[124:127], v3, s[24:27], s3 offen offset:1024 sc1
    s_add_u32 s3, s6, 20480
    buffer_load_dwordx4 v[128:131], v3, s[24:27], s3 offen offset:0 sc1
    s_add_u32 s3, s3, s8
    buffer_load_dwordx4 v[136:139], v3, s[24:27], s3 offen offset:1024 sc1
    s_add_u32 s3, s7, 20480
    buffer_load_dwordx4 v[132:135], v3, s[24:27], s3 offen offset:0 sc1
    s_add_u32 s3, s3, s8
    buffer_load_dwordx4 v[140:143], v3, s[24:27], s3 offen offset:1024 sc1
    s_add_u32 s57, s57, 1
    s_waitcnt vmcnt(0)
    s_cmp_ge_u32 s57, 100000
    s_cbranch_scc1 RX_116
    v_max3_u32 v13, v112, v116, v120
    v_max3_u32 v13, v13, v124, v128
    v_max3_u32 v13, v13, v132, v136
    v_max_u32 v13, v13, v140
    v_cmp_eq_u32 vcc, -1, v13
    s_cbranch_vccnz RT_67
    s_cmp_eq_u32 exec_lo, -1
    s_mov_b64 exec, -1
    s_cbranch_scc0 RL_115
RX_116:
    s_mov_b64 exec, -1
    s_nop 3
    s_branch BK_68
RT_69:
    s_nop 7
    s_nop 7
    s_mov_b32 exec_lo, 0
    s_mov_b32 exec_hi, 0x80000000
RL_117:
    s_add_u32 s3, s6, 20480
    buffer_load_dwordx4 v[128:131], v3, s[24:27], s3 offen offset:0 sc1
    s_add_u32 s3, s3, s8
    buffer_load_dwordx4 v[136:139], v3, s[24:27], s3 offen offset:1024 sc1
    s_add_u32 s3, s7, 20480
    buffer_load_dwordx4 v[132:135], v3, s[24:27], s3 offen offset:0 sc1
    s_add_u32 s3, s3, s8
    buffer_load_dwordx4 v[140:143], v3, s[24:27], s3 offen offset:1024 sc1
    s_add_u32 s57, s57, 1
    s_waitcnt vmcnt(0)
    s_cmp_ge_u32 s57, 100000
    s_cbranch_scc1 RX_118
    v_max3_u32 v13, v128, v132, v136
    v_max_u32 v13, v13, v140
    v_cmp_eq_u32 vcc, -1, v13
    s_cbranch_vccnz RT_69
    s_cmp_eq_u32 exec_lo, -1
    s_mov_b64 exec, -1
    s_cbranch_scc0 RL_117
RX_118:
    s_mov_b64 exec, -1
    s_nop 3
    s_branch BK_70
L_CODE_END:
    s_endpgm
.section .rodata,"a"
.p2align 6
.amdhsa_kernel adaLN_cond__linear_kernel_hedgehog__glu_gated_bilinear__prompt_kernel
  .amdhsa_next_free_vgpr 512
  .amdhsa_next_free_sgpr 100
  .amdhsa_accum_offset 256
  .amdhsa_group_segment_fixed_size 0
  .amdhsa_kernarg_size 104
  .amdhsa_user_sgpr_count 2
  .amdhsa_user_sgpr_kernarg_segment_ptr 1
  .amdhsa_system_sgpr_workgroup_id_x 1
.end_amdhsa_kernel
```
